```python
import torch

def _softmax(x, axis=-1):
    return torch.softmax(x, dim=axis)
def _gelu(x):
    return torch.nn.functional.gelu(x, approximate="tanh")
def _silu(x):
    return torch.nn.functional.silu(x)
def _sigmoid(x):
    return torch.sigmoid(x)
def _layernorm(x, axis=-1, eps=1e-5):
    m = x.mean(dim=axis, keepdim=True)
    v = x.var(dim=axis, keepdim=True, unbiased=False)
    return (x - m) / torch.sqrt(v + eps)
def _scatter_add(tgt, idx, src, axis=0):
    return tgt.clone().index_add_(axis, idx, src)
def _segment_sum(src, seg, n):
    out = torch.zeros((n,) + src.shape[1:], dtype=src.dtype)
    return out.index_add_(0, seg, src)
def _pad(x, pw):
    flat = tuple(v for pair in reversed(pw) for v in pair)
    return torch.nn.functional.pad(x, flat)

kernel_name = 'interleave_layers__linear_attn_block__ssm_conv_s4__prompt'

def setup_inputs():

    _w = (lambda a: (lambda t: t.to(torch.bfloat16) if t.is_floating_point() else t)(torch.as_tensor(a)))
    def _A_setup():
        B, S, D = 1, 2048, 512
        return {
            "x": _w((lambda *s: torch.randn(*s, dtype=torch.bfloat16) * 0.05)(B, S, D)),
            "wqkv": _w((lambda *s: torch.randn(*s, dtype=torch.bfloat16) * 0.05)(D, 3 * D)),
            "wo": _w((lambda *s: torch.randn(*s, dtype=torch.bfloat16) * 0.05)(D, D)),
        }
    _A_in = _A_setup()

    def _B_setup():
        B, L, D, N = 1, 2048, 512, 128
        A_re = -(lambda _x: torch.exp(torch.as_tensor(_x)))((lambda *s: torch.randn(*s, dtype=torch.bfloat16) * 1.6)(D, N))
        A_im = torch.pi * (lambda *s: torch.randn(*s, dtype=torch.bfloat16) * 0.1)(D, N)
        B_re = (lambda *s: torch.randn(*s, dtype=torch.bfloat16) * 0.1)(D, N)
        B_im = (lambda *s: torch.randn(*s, dtype=torch.bfloat16) * 0.1)(D, N)
        C_re = (lambda *s: torch.randn(*s, dtype=torch.bfloat16) * 0.1)(D, N)
        C_im = (lambda *s: torch.randn(*s, dtype=torch.bfloat16) * 0.1)(D, N)
        log_dt = (lambda *s: torch.randn(*s, dtype=torch.bfloat16) * 0.1)(D) * 0.5 - 4.0
        Dskip = (lambda *s: torch.randn(*s, dtype=torch.bfloat16) * 0.1)(D)
        return {
            "u": _w((lambda *s: torch.randn(*s, dtype=torch.bfloat16) * 0.05)(B, L, D)),
            "A_re": _w(A_re),
            "A_im": _w(A_im),
            "B_re": _w(B_re),
            "B_im": _w(B_im),
            "C_re": _w(C_re),
            "C_im": _w(C_im),
            "log_dt": _w(log_dt),
            "Dskip": _w(Dskip),
        }
    _B_in = _B_setup()

    return {
        "A_x": _A_in["x"],
        "A_wqkv": _A_in["wqkv"],
        "A_wo": _A_in["wo"],
        "B_u": _B_in["u"],
        "B_A_re": _B_in["A_re"],
        "B_A_im": _B_in["A_im"],
        "B_B_re": _B_in["B_re"],
        "B_B_im": _B_in["B_im"],
        "B_C_re": _B_in["C_re"],
        "B_C_im": _B_in["C_im"],
        "B_log_dt": _B_in["log_dt"],
        "B_Dskip": _B_in["Dskip"],
    }

def reference(A_x, A_wqkv, A_wo, B_u, B_A_re, B_A_im, B_B_re, B_B_im, B_C_re, B_C_im, B_log_dt, B_Dskip):
    def _A_ref(x, wqkv, wo):
        B, S, D = x.shape
        H = 32; Dh = D // H
        qkv = (lambda x, *d: x.permute(*d))((x @ wqkv).reshape(B, S, 3, H, Dh), 2, 0, 3, 1, 4)
        q, k, v = qkv[0], qkv[1], qkv[2]
        phi = lambda t: torch.where(t > 0, t + 1, torch.exp(t)) + 1e-6
        pq, pk = phi(q), phi(k)
        kv = torch.einsum("bhsd,bhse->bhde", pk, v)
        z = torch.einsum("bhsd->bhd", pk)
        num = torch.einsum("bhqd,bhde->bhqe", pq, kv)
        den = torch.einsum("bhqd,bhd->bhq", pq, z)[..., None] + 1e-6
        o = num / den
        return (lambda x, *d: x.permute(*d))(o, 0, 2, 1, 3).reshape(B, S, D) @ wo

    def _B_ref(u, A_re, A_im, B_re, B_im, C_re, C_im, log_dt, Dskip):
        Bsz, L, D = u.shape
        dt = torch.exp(log_dt)[:, None]
        A = A_re + 1j * A_im
        Bc = B_re + 1j * B_im
        Cc = C_re + 1j * C_im
        logdA = dt * A
        dB = dt * Bc
        l = (lambda x, dt: x.to(dt))(torch.arange(L), A_re.dtype)
        P = torch.exp(logdA[:, :, None] * l[None, None, :])
        K = torch.einsum("dn,dnl,dn->dl", Cc, P, dB).real
        L2 = 2 * L
        Kp = _pad(K, ((0, 0), (0, L)))
        up = (lambda x, *d: x.permute(*d))(u, 0, 2, 1)
        up = _pad(up, ((0, 0), (0, 0), (0, L)))
        Kf = (lambda x, axes=(-2,-1): torch.fft.rfft2(x.float(), dim=axes))(Kp[:, None, :], axes=(-2, -1))
        Uf = (lambda x, axes=(-2,-1): torch.fft.rfft2(x.float(), dim=axes))(up[:, :, None, :], axes=(-2, -1))
        Yf = Uf * Kf[None, :, :, :]
        y = (lambda x, s, axes=(-2,-1): torch.fft.irfft2(x, s=s, dim=axes).to(torch.bfloat16))(Yf, (1, L2), axes=(-2, -1))[:, :, 0, :L]
        y = (lambda x, *d: x.permute(*d))(y, 0, 2, 1) + u * Dskip[None, None, :]
        return y

    x = A_x
    x = x + _A_ref(_layernorm(x, axis=-1), A_wqkv, A_wo)
    x = x + _B_ref(_layernorm(x, axis=-1), B_A_re, B_A_im, B_B_re, B_B_im, B_C_re, B_C_im, B_log_dt, B_Dskip)
    x = x + _A_ref(_layernorm(x, axis=-1), A_wqkv, A_wo)
    x = x + _B_ref(_layernorm(x, axis=-1), B_A_re, B_A_im, B_B_re, B_B_im, B_C_re, B_C_im, B_log_dt, B_Dskip)
    return x
```

```asm
; @launch grid=(256,1,1) block=(512,1,1) lds=163840
.amdgcn_target "amdgcn-amd-amdhsa--gfx950"
.text
.globl interleave_layers__linear_attn_block__ssm_conv_s4__prompt_kernel
.p2align 8
.type interleave_layers__linear_attn_block__ssm_conv_s4__prompt_kernel,@function
interleave_layers__linear_attn_block__ssm_conv_s4__prompt_kernel:
    s_cmp_ge_u32 s2, 256
    s_cbranch_scc1 L_exit
    s_load_dwordx2 s[12:13], s[0:1], 0
    s_load_dwordx2 s[16:17], s[0:1], 8
    s_load_dwordx2 s[20:21], s[0:1], 112
    s_load_dwordx2 s[60:61], s[0:1], 16
    s_load_dwordx2 s[64:65], s[0:1], 96
    s_load_dwordx2 s[4:5], s[0:1], 88
    v_lshrrev_b32 v2, 6, v0
    v_and_b32 v1, 63, v0
    s_and_b32 s36, s2, 7
    s_lshr_b32 s37, s2, 3
    v_readfirstlane_b32 s28, v2
    s_mov_b32 s68, 0
    s_mov_b32 s69, 0
    s_mov_b32 s7, 0xeb8000
    s_mov_b32 s14, 0x200000
    s_mov_b32 s15, 0x20000
    s_mov_b32 s18, 0x180000
    s_mov_b32 s19, 0x20000
    s_mov_b32 s22, 0xf80000
    s_mov_b32 s23, 0x20000
    s_mov_b32 s62, 0x80000
    s_mov_b32 s63, 0x20000
    s_mov_b32 s66, 0x200000
    s_mov_b32 s67, 0x20000
L_A:
    s_cmp_ge_u32 s37, 24
    s_cbranch_scc1 L_stat
    s_lshr_b32 s30, s37, 2
    s_and_b32 s29, s36, 3
    s_lshl_b32 s29, s29, 2
    s_and_b32 s38, s37, 3
    s_add_u32 s29, s29, s38
    s_lshr_b32 s31, s36, 2
    s_lshl_b32 s34, s31, 2
    s_add_u32 s34, s34, s30
    s_lshl_b32 s35, s31, 1
    s_add_u32 s35, s35, s30
    s_sub_u32 s35, s35, 4
    s_cmp_lt_u32 s28, 4
    s_cbranch_scc1 L_Amain
    s_cmp_lg_u32 s68, 0
    s_cbranch_scc1 L_Aload1
    s_sub_u32 s41, s28, 4
    s_lshl_b32 s33, s38, 1
    s_add_u32 s33, s33, s30
    s_add_u32 s33, s33, s36
    s_and_b32 s53, s33, 0
    v_lshrrev_b32 v10, 4, v1
    v_and_b32 v11, 15, v1
    v_lshlrev_b32 v12, 2, v10
    v_xor_b32 v11, v11, v12
    s_lshl_b32 s43, s41, 4
    v_add_u32 v12, s43, v10
    s_lshl_b32 s50, s34, 7
    s_add_u32 s50, s50, 1024
    s_lshl_b32 s52, s35, 8
    s_cmp_ge_u32 s30, 4
    s_cselect_b32 s49, 0, 896
    s_cselect_b32 s50, s52, s50
    v_lshrrev_b32 v13, 3, v11
    v_mul_u32_u24 v13, s49, v13
    v_lshl_add_u32 v13, v11, 4, v13
    v_mul_u32_u24 v6, 3072, v12
    v_add_u32 v6, v6, v13
    v_add_u32 v7, 11264, v6
    v_add_u32 v8, 22528, v6
    v_add_u32 v9, 33792, v6
    s_lshl_b32 s52, s41, 12
    v_lshrrev_b32 v14, 3, v1
    s_lshl_b32 s43, s41, 5
    v_add_u32 v14, s43, v14
    v_lshlrev_b32 v14, 10, v14
    v_and_b32 v15, 7, v1
    v_xor_b32 v15, v15, v10
    v_lshl_add_u32 v2, v15, 4, v14
    v_xor_b32 v3, 64, v2
    v_add_u32 v3, 7168, v3
    v_add_u32 v4, 14336, v2
    v_add_u32 v5, 14336, v3
    s_lshl_b32 s51, s29, 17
    s_waitcnt lgkmcnt(0)
    s_add_u32 s54, s53, 0
    s_and_b32 s54, s54, 7
    s_lshl_b32 s54, s54, 7
    s_add_u32 m0, s52, 0
    s_add_u32 s54, s54, s51
    buffer_load_dwordx4 v2, s[12:15], s54 offen offset:0  lds
    buffer_load_dwordx4 v3, s[12:15], s54 offen offset:1024  lds
    buffer_load_dwordx4 v4, s[12:15], s54 offen offset:2048  lds
    buffer_load_dwordx4 v5, s[12:15], s54 offen offset:3072  lds
    s_add_u32 s55, s53, 0
    s_and_b32 s55, s55, 7
    s_mul_i32 s55, s55, 196608
    s_add_u32 m0, s52, 65536
    s_add_u32 s55, s55, s50
    buffer_load_dwordx4 v6, s[16:19], s55 offen offset:0 lds
    buffer_load_dwordx4 v7, s[16:19], s55 offen offset:1024 lds
    buffer_load_dwordx4 v8, s[16:19], s55 offen offset:2048 lds
    buffer_load_dwordx4 v9, s[16:19], s55 offen offset:3072 lds
    s_add_u32 s54, s53, 1
    s_and_b32 s54, s54, 7
    s_lshl_b32 s54, s54, 7
    s_add_u32 m0, s52, 16384
    s_add_u32 s54, s54, s51
    buffer_load_dwordx4 v2, s[12:15], s54 offen offset:0  lds
    buffer_load_dwordx4 v3, s[12:15], s54 offen offset:1024  lds
    buffer_load_dwordx4 v4, s[12:15], s54 offen offset:2048  lds
    buffer_load_dwordx4 v5, s[12:15], s54 offen offset:3072  lds
    s_add_u32 s55, s53, 1
    s_and_b32 s55, s55, 7
    s_mul_i32 s55, s55, 196608
    s_add_u32 m0, s52, 81920
    s_add_u32 s55, s55, s50
    buffer_load_dwordx4 v6, s[16:19], s55 offen offset:0 lds
    buffer_load_dwordx4 v7, s[16:19], s55 offen offset:1024 lds
    buffer_load_dwordx4 v8, s[16:19], s55 offen offset:2048 lds
    buffer_load_dwordx4 v9, s[16:19], s55 offen offset:3072 lds
    s_load_dword s6, s[20:21], s7
    v_lshlrev_b32 v21, 4, v1
    v_and_b32 v19, 15, v1
    v_lshlrev_b32 v19, 8, v19
    v_add_u32 v19, 0xeb2000, v19
    s_lshl_b32 s58, s29, 1
    s_add_u32 s58, s58, s41
    s_lshl_b32 s58, s58, 11
    s_add_u32 s58, s58, 0x410000
    s_and_b32 s59, s41, 1
    s_add_u32 s43, s49, 128
    s_mul_i32 s59, s59, s43
    s_add_u32 s59, s59, s50
    s_lshl_b32 s59, s59, 4
    s_add_u32 s59, s59, 0xea0000
    s_cmp_ge_u32 s41, 2
    s_cselect_b32 s58, s59, s58
    s_waitcnt vmcnt(8)
    s_barrier
    s_add_u32 s54, s53, 2
    s_and_b32 s54, s54, 7
    s_lshl_b32 s54, s54, 7
    s_add_u32 m0, s52, 32768
    s_add_u32 s54, s54, s51
    buffer_load_dwordx4 v2, s[12:15], s54 offen offset:0  lds
    buffer_load_dwordx4 v3, s[12:15], s54 offen offset:1024  lds
    buffer_load_dwordx4 v4, s[12:15], s54 offen offset:2048  lds
    buffer_load_dwordx4 v5, s[12:15], s54 offen offset:3072  lds
    s_add_u32 s55, s53, 2
    s_and_b32 s55, s55, 7
    s_mul_i32 s55, s55, 196608
    s_add_u32 m0, s52, 98304
    s_add_u32 s55, s55, s50
    buffer_load_dwordx4 v6, s[16:19], s55 offen offset:0 lds
    buffer_load_dwordx4 v7, s[16:19], s55 offen offset:1024 lds
    buffer_load_dwordx4 v8, s[16:19], s55 offen offset:2048 lds
    buffer_load_dwordx4 v9, s[16:19], s55 offen offset:3072 lds
    s_add_u32 s54, s53, 3
    s_and_b32 s54, s54, 7
    s_lshl_b32 s54, s54, 7
    s_add_u32 m0, s52, 49152
    s_add_u32 s54, s54, s51
    buffer_load_dwordx4 v2, s[12:15], s54 offen offset:0  lds
    buffer_load_dwordx4 v3, s[12:15], s54 offen offset:1024  lds
    buffer_load_dwordx4 v4, s[12:15], s54 offen offset:2048  lds
    buffer_load_dwordx4 v5, s[12:15], s54 offen offset:3072  lds
    s_add_u32 s55, s53, 3
    s_and_b32 s55, s55, 7
    s_mul_i32 s55, s55, 196608
    s_add_u32 m0, s52, 114688
    s_add_u32 s55, s55, s50
    buffer_load_dwordx4 v6, s[16:19], s55 offen offset:0 lds
    buffer_load_dwordx4 v7, s[16:19], s55 offen offset:1024 lds
    buffer_load_dwordx4 v8, s[16:19], s55 offen offset:2048 lds
    buffer_load_dwordx4 v9, s[16:19], s55 offen offset:3072 lds
    s_waitcnt vmcnt(16)
    s_barrier
    s_add_u32 s54, s53, 4
    s_and_b32 s54, s54, 7
    s_lshl_b32 s54, s54, 7
    s_add_u32 m0, s52, 0
    s_add_u32 s54, s54, s51
    buffer_load_dwordx4 v2, s[12:15], s54 offen offset:0  lds
    buffer_load_dwordx4 v3, s[12:15], s54 offen offset:1024  lds
    buffer_load_dwordx4 v4, s[12:15], s54 offen offset:2048  lds
    buffer_load_dwordx4 v5, s[12:15], s54 offen offset:3072  lds
    s_add_u32 s55, s53, 4
    s_and_b32 s55, s55, 7
    s_mul_i32 s55, s55, 196608
    s_add_u32 m0, s52, 65536
    s_add_u32 s55, s55, s50
    buffer_load_dwordx4 v6, s[16:19], s55 offen offset:0 lds
    buffer_load_dwordx4 v7, s[16:19], s55 offen offset:1024 lds
    buffer_load_dwordx4 v8, s[16:19], s55 offen offset:2048 lds
    buffer_load_dwordx4 v9, s[16:19], s55 offen offset:3072 lds
    s_waitcnt vmcnt(16)
    s_barrier
    s_add_u32 s54, s53, 5
    s_and_b32 s54, s54, 7
    s_lshl_b32 s54, s54, 7
    s_add_u32 m0, s52, 16384
    s_add_u32 s54, s54, s51
    buffer_load_dwordx4 v2, s[12:15], s54 offen offset:0  lds
    buffer_load_dwordx4 v3, s[12:15], s54 offen offset:1024  lds
    buffer_load_dwordx4 v4, s[12:15], s54 offen offset:2048  lds
    buffer_load_dwordx4 v5, s[12:15], s54 offen offset:3072  lds
    s_add_u32 s55, s53, 5
    s_and_b32 s55, s55, 7
    s_mul_i32 s55, s55, 196608
    s_add_u32 m0, s52, 81920
    s_add_u32 s55, s55, s50
    buffer_load_dwordx4 v6, s[16:19], s55 offen offset:0 lds
    buffer_load_dwordx4 v7, s[16:19], s55 offen offset:1024 lds
    buffer_load_dwordx4 v8, s[16:19], s55 offen offset:2048 lds
    buffer_load_dwordx4 v9, s[16:19], s55 offen offset:3072 lds
    s_waitcnt vmcnt(16)
    s_barrier
    s_add_u32 s54, s53, 6
    s_and_b32 s54, s54, 7
    s_lshl_b32 s54, s54, 7
    s_add_u32 m0, s52, 32768
    s_add_u32 s54, s54, s51
    buffer_load_dwordx4 v2, s[12:15], s54 offen offset:0  lds
    buffer_load_dwordx4 v3, s[12:15], s54 offen offset:1024  lds
    buffer_load_dwordx4 v4, s[12:15], s54 offen offset:2048  lds
    buffer_load_dwordx4 v5, s[12:15], s54 offen offset:3072  lds
    s_add_u32 s55, s53, 6
    s_and_b32 s55, s55, 7
    s_mul_i32 s55, s55, 196608
    s_add_u32 m0, s52, 98304
    s_add_u32 s55, s55, s50
    buffer_load_dwordx4 v6, s[16:19], s55 offen offset:0 lds
    buffer_load_dwordx4 v7, s[16:19], s55 offen offset:1024 lds
    buffer_load_dwordx4 v8, s[16:19], s55 offen offset:2048 lds
    buffer_load_dwordx4 v9, s[16:19], s55 offen offset:3072 lds
    s_waitcnt vmcnt(16)
    s_barrier
    s_add_u32 s54, s53, 7
    s_and_b32 s54, s54, 7
    s_lshl_b32 s54, s54, 7
    s_add_u32 m0, s52, 49152
    s_add_u32 s54, s54, s51
    buffer_load_dwordx4 v2, s[12:15], s54 offen offset:0  lds
    buffer_load_dwordx4 v3, s[12:15], s54 offen offset:1024  lds
    buffer_load_dwordx4 v4, s[12:15], s54 offen offset:2048  lds
    buffer_load_dwordx4 v5, s[12:15], s54 offen offset:3072  lds
    s_add_u32 s55, s53, 7
    s_and_b32 s55, s55, 7
    s_mul_i32 s55, s55, 196608
    s_add_u32 m0, s52, 114688
    s_add_u32 s55, s55, s50
    buffer_load_dwordx4 v6, s[16:19], s55 offen offset:0 lds
    buffer_load_dwordx4 v7, s[16:19], s55 offen offset:1024 lds
    buffer_load_dwordx4 v8, s[16:19], s55 offen offset:2048 lds
    buffer_load_dwordx4 v9, s[16:19], s55 offen offset:3072 lds
    s_waitcnt vmcnt(16)
    s_barrier
    s_waitcnt vmcnt(8)
    s_barrier
    buffer_load_dwordx4 v[24:27], v21, s[20:23], s58 offen offset:0 sc1
    buffer_load_dwordx4 v[28:31], v21, s[20:23], s58 offen offset:1024 sc1
    buffer_load_dword v20, v19, s[20:23], 0 offen sc1
    s_waitcnt vmcnt(3)
    s_barrier
    s_lshl_b32 s43, s41, 8
    s_add_u32 s43, s43, 131072
    v_lshl_add_u32 v18, v1, 2, s43
    s_mov_b32 s57, 0
    s_waitcnt lgkmcnt(0)
    s_add_u32 s6, s6, 8
L_pchk_A0:
    s_waitcnt vmcnt(0)
    v_xor_b32 v22, s6, v25
    v_xor_b32 v23, s6, v27
    v_or_b32 v22, v22, v23
    v_xor_b32 v23, s6, v29
    v_or_b32 v22, v22, v23
    v_xor_b32 v23, s6, v31
    v_or_b32 v22, v22, v23
    v_cmp_ne_u32 vcc, 0, v22
    s_cbranch_vccz L_pok_A0
    s_add_u32 s57, s57, 1
    s_cmp_gt_u32 s57, 200000
    s_cbranch_scc1 L_pok_A0
    s_sleep 4
    buffer_load_dwordx4 v[24:27], v21, s[20:23], s58 offen offset:0 sc1
    buffer_load_dwordx4 v[28:31], v21, s[20:23], s58 offen offset:1024 sc1
    s_branch L_pchk_A0
L_pok_A0:
    v_add_f32 v22, v24, v28
    v_add_f32 v23, v26, v30
    s_cmp_ge_u32 s41, 2
    s_cbranch_scc1 L_lcs_A0
    v_mul_f32 v22, 0xbb000000, v22
    v_mul_f32 v24, v22, v22
    v_mov_b32 v25, 0x3b000000
    v_fma_f32 v23, v23, v25, -v24
    v_max_f32 v23, 0, v23
    v_add_f32 v23, 0x3727c5ac, v23
    v_rsq_f32 v23, v23
    ds_write_b32 v18, v22
    v_mul_f32 v24, 0x3fb8aa3b, v23
    ds_write_b32 v18, v23 offset:512
    ds_write_b32 v18, v24 offset:1024
    s_branch L_lcs2_A0
L_lcs_A0:
    ds_write_b32 v18, v22 offset:1024
L_lcs2_A0:
    s_waitcnt lgkmcnt(0)
    s_barrier
    s_mov_b32 s57, 0
    s_mov_b64 exec, 0xffff
L_ic_A0:
    v_cmp_ne_u32 vcc, s6, v20
    s_cbranch_vccz L_io_A0
    s_add_u32 s57, s57, 1
    s_cmp_gt_u32 s57, 200000
    s_cbranch_scc1 L_io_A0
    s_sleep 8
    buffer_load_dword v20, v19, s[20:23], 0 offen sc1
    s_waitcnt vmcnt(0)
    s_branch L_ic_A0
L_io_A0:
    s_mov_b64 exec, -1
    s_branch L_Altail
L_stat:
    s_sub_u32 s29, s37, 24
    s_lshl_b32 s29, s29, 3
    s_add_u32 s29, s29, s36
    s_lshr_b32 s38, s29, 1
    s_and_b32 s39, s29, 1
    s_cmp_lg_u32 s68, 0
    s_cbranch_scc1 L_stat1
    s_load_dwordx8 s[44:51], s[0:1], 32
    s_load_dwordx4 s[52:55], s[0:1], 64
    s_load_dwordx2 s[56:57], s[0:1], 80
    s_lshl_b32 s58, s29, 3
    s_add_u32 s58, s58, s28
    s_lshl_b32 s31, s58, 8
    v_lshl_add_u32 v230, v1, 2, s31
    s_lshl_b32 s31, s58, 1
    v_mov_b32 v231, s31
    v_lshrrev_b32 v140, 3, v1
    v_and_b32 v141, 7, v1
    v_lshlrev_b32 v142, 4, v141
    v_lshl_add_u32 v142, v140, 10, v142
    s_lshl_b32 s41, s38, 16
    s_lshl_b32 s31, s28, 13
    s_add_u32 s41, s41, s31
    s_lshl_b32 s31, s39, 9
    s_add_u32 s41, s41, s31
    s_waitcnt lgkmcnt(0)
    buffer_load_dwordx4 v[210:213], v142, s[12:15], s41 offen offset:0
    buffer_load_dwordx4 v[214:217], v142, s[12:15], s41 offen offset:128
    buffer_load_dwordx4 v[218:221], v142, s[12:15], s41 offen offset:256
    buffer_load_dwordx4 v[222:225], v142, s[12:15], s41 offen offset:384
    s_load_dword s6, s[20:21], s7
    s_cmp_ge_u32 s29, 48
    s_cbranch_scc1 L_st_zero
    v_lshrrev_b32 v156, 3, v1
    v_and_b32 v157, 7, v1
    v_bfe_u32 v158, v1, 4, 1
    v_lshlrev_b32 v158, 2, v158
    v_xor_b32 v157, v157, v158
    v_lshlrev_b32 v157, 4, v157
    v_mul_u32_u24 v150, 3072, v156
    v_add_u32 v150, v150, v157
    v_add_u32 v151, 23552, v150
    v_add_u32 v152, 47104, v150
    v_add_u32 v153, 70656, v150
    v_lshrrev_b32 v156, 5, v1
    v_bfe_u32 v157, v1, 2, 2
    v_lshl_add_u32 v154, v156, 3, v157
    v_lshlrev_b32 v154, 7, v154
    v_lshl_add_u32 v154, v158, 3, v154
    v_and_b32 v158, 3, v1
    v_lshl_add_u32 v154, v158, 3, v154
    v_lshrrev_b32 v157, 1, v157
    v_lshl_add_u32 v154, v157, 6, v154
    s_lshl_b32 s40, s28, 12
    v_add_u32 v154, s40, v154
    v_xor_b32 v155, 64, v154
    s_mov_b32 m0, s40
    s_mul_i32 s43, s39, 786432
    s_mul_i32 s31, s28, 98304
    s_add_u32 s43, s43, s31
    s_lshl_b32 s31, s38, 7
    s_add_u32 s43, s43, s31
    buffer_load_dwordx4 v150, s[16:19], s43 offen offset:0 lds
    buffer_load_dwordx4 v151, s[16:19], s43 offen offset:1024 lds
    buffer_load_dwordx4 v152, s[16:19], s43 offen offset:2048 lds
    buffer_load_dwordx4 v153, s[16:19], s43 offen offset:3072 lds
    global_load_ushort v238, v231, s[56:57]
    global_load_dword v232, v230, s[44:45]
    global_load_dword v233, v230, s[46:47]
    global_load_dword v234, v230, s[48:49]
    global_load_dword v235, v230, s[50:51]
    global_load_dword v236, v230, s[52:53]
    global_load_dword v237, v230, s[54:55]
    s_waitcnt vmcnt(11) lgkmcnt(0)
    s_add_u32 s6, s6, 8
    s_branch L_pub_I
L_st_zero:
    v_mov_b32 v190, 0
    v_mov_b32 v191, 0
    v_mov_b32 v192, 0
    v_mov_b32 v193, 0
    v_lshlrev_b32 v194, 4, v0
    s_and_b32 s33, s29, 7
    s_mul_i32 s33, s33, 6656
    s_bfe_u32 s31, s29, 0x10003
    s_mul_i32 s31, s31, 0x440000
    s_add_u32 s33, s33, s31
    s_add_u32 s33, s33, 0x400000
    s_and_b32 s31, s29, 15
    s_lshl_b32 s31, s31, 8
    s_add_u32 s31, s31, 0xeae600
    v_mov_b32 v195, s33
    v_mov_b32 v200, s31
    v_cmp_gt_u32 vcc, 416, v0
    s_nop 1
    v_cndmask_b32 v195, v200, v195, vcc
    s_and_b32 s31, s29, 15
    s_lshl_b32 s31, s31, 10
    s_add_u32 s31, s31, 0xebe500
    v_mov_b32 v200, s31
    v_cmp_gt_u32 vcc, 432, v0
    s_nop 1
    v_cndmask_b32 v195, v200, v195, vcc
    v_add_u32 v194, v194, v195
    v_cmp_gt_u32 vcc, 496, v0
    s_nop 0
    s_and_saveexec_b64 s[34:35], vcc
    s_cbranch_execz L_st_nz
    buffer_store_dwordx4 v[190:193], v194, s[20:23], 0 offen sc0 sc1
L_st_nz:
    s_mov_b64 exec, -1
    global_load_ushort v238, v231, s[56:57]
    global_load_dword v232, v230, s[44:45]
    global_load_dword v233, v230, s[46:47]
    global_load_dword v234, v230, s[48:49]
    global_load_dword v235, v230, s[50:51]
    global_load_dword v236, v230, s[52:53]
    global_load_dword v237, v230, s[54:55]
    s_waitcnt lgkmcnt(0)
    s_add_u32 s6, s6, 8
    s_waitcnt vmcnt(0) lgkmcnt(0)
    s_barrier
    s_cmp_lg_u32 s28, 0
    s_cbranch_scc1 L_pub_I
    s_lshl_b32 s31, s29, 8
    s_add_u32 s31, s31, 0xeaf000
    v_mov_b32 v2, s6
    v_mov_b32 v3, 0
    s_mov_b64 exec, 1
    buffer_store_dword v2, v3, s[20:23], s31 offen sc0 sc1
    s_mov_b64 exec, -1
L_pub_I:
    v_mov_b32 v196, 0
    v_mov_b32 v197, 0
    v_mov_b32 v198, 0
    v_mov_b32 v199, 0
    s_mov_b32 s48, 0x3f803f80
    v_dot2c_f32_bf16 v196, s48, v210
    v_dot2c_f32_bf16 v198, v210, v210
    v_dot2c_f32_bf16 v197, s48, v211
    v_dot2c_f32_bf16 v199, v211, v211
    v_dot2c_f32_bf16 v196, s48, v212
    v_dot2c_f32_bf16 v198, v212, v212
    v_dot2c_f32_bf16 v197, s48, v213
    v_dot2c_f32_bf16 v199, v213, v213
    v_dot2c_f32_bf16 v196, s48, v214
    v_dot2c_f32_bf16 v198, v214, v214
    v_dot2c_f32_bf16 v197, s48, v215
    v_dot2c_f32_bf16 v199, v215, v215
    v_dot2c_f32_bf16 v196, s48, v216
    v_dot2c_f32_bf16 v198, v216, v216
    v_dot2c_f32_bf16 v197, s48, v217
    v_dot2c_f32_bf16 v199, v217, v217
    v_dot2c_f32_bf16 v196, s48, v218
    v_dot2c_f32_bf16 v198, v218, v218
    v_dot2c_f32_bf16 v197, s48, v219
    v_dot2c_f32_bf16 v199, v219, v219
    v_dot2c_f32_bf16 v196, s48, v220
    v_dot2c_f32_bf16 v198, v220, v220
    v_dot2c_f32_bf16 v197, s48, v221
    v_dot2c_f32_bf16 v199, v221, v221
    v_dot2c_f32_bf16 v196, s48, v222
    v_dot2c_f32_bf16 v198, v222, v222
    v_dot2c_f32_bf16 v197, s48, v223
    v_dot2c_f32_bf16 v199, v223, v223
    v_dot2c_f32_bf16 v196, s48, v224
    v_dot2c_f32_bf16 v198, v224, v224
    v_dot2c_f32_bf16 v197, s48, v225
    v_dot2c_f32_bf16 v199, v225, v225
    s_nop 1
    v_add_f32 v196, v196, v197
    v_add_f32 v198, v198, v199
    s_nop 0
    v_add_f32_dpp v196, v196, v196 quad_perm:[1,0,3,2] row_mask:0xf bank_mask:0xf
    v_add_f32_dpp v198, v198, v198 quad_perm:[1,0,3,2] row_mask:0xf bank_mask:0xf
    s_nop 0
    v_add_f32_dpp v196, v196, v196 quad_perm:[2,3,0,1] row_mask:0xf bank_mask:0xf
    v_add_f32_dpp v198, v198, v198 quad_perm:[2,3,0,1] row_mask:0xf bank_mask:0xf
    s_nop 0
    v_add_f32_dpp v196, v196, v196 row_half_mirror row_mask:0xf bank_mask:0xf
    v_add_f32_dpp v198, v198, v198 row_half_mirror row_mask:0xf bank_mask:0xf
    v_mov_b32 v197, s6
    v_mov_b32 v199, s6
    v_lshlrev_b32 v200, 4, v140
    s_lshl_b32 s42, s29, 10
    s_lshl_b32 s31, s28, 7
    s_add_u32 s31, s31, s42
    s_add_u32 s31, s31, 0x410000
    s_waitcnt vmcnt(0)
    s_mov_b32 exec_lo, 0x01010101
    s_mov_b32 exec_hi, 0x01010101
    buffer_store_dwordx4 v[196:199], v200, s[20:23], s31 offen sc1
    s_mov_b64 exec, -1
    s_add_u32 s42, s42, 0xea0000
    s_cmp_ge_u32 s29, 48
    s_cbranch_scc1 L_cs_S0
    ds_read_b64_tr_b16 v[162:163], v154 offset:0
    ds_read_b64_tr_b16 v[164:165], v154 offset:512
    ds_read_b64_tr_b16 v[166:167], v154 offset:2048
    ds_read_b64_tr_b16 v[168:169], v154 offset:2560
    ds_read_b64_tr_b16 v[170:171], v155 offset:0
    ds_read_b64_tr_b16 v[172:173], v155 offset:512
    ds_read_b64_tr_b16 v[174:175], v155 offset:2048
    ds_read_b64_tr_b16 v[176:177], v155 offset:2560
    v_mov_b32 v178, 0
    v_mov_b32 v179, 0
    v_mov_b32 v180, 0
    v_mov_b32 v181, 0
    s_mov_b32 s48, 0x3f803f80
    s_lshl_b32 s40, s28, 9
    s_add_u32 s40, s40, 137216
    v_lshl_add_u32 v156, v1, 2, s40
    s_waitcnt lgkmcnt(0)
    v_dot2c_f32_bf16 v178, s48, v162
    v_dot2c_f32_bf16 v179, s48, v170
    v_dot2c_f32_bf16 v178, s48, v163
    v_dot2c_f32_bf16 v179, s48, v171
    v_dot2c_f32_bf16 v178, s48, v164
    v_dot2c_f32_bf16 v179, s48, v172
    v_dot2c_f32_bf16 v178, s48, v165
    v_dot2c_f32_bf16 v179, s48, v173
    v_dot2c_f32_bf16 v178, s48, v166
    v_dot2c_f32_bf16 v179, s48, v174
    v_dot2c_f32_bf16 v178, s48, v167
    v_dot2c_f32_bf16 v179, s48, v175
    v_dot2c_f32_bf16 v178, s48, v168
    v_dot2c_f32_bf16 v179, s48, v176
    v_dot2c_f32_bf16 v178, s48, v169
    v_dot2c_f32_bf16 v179, s48, v177
    s_nop 2
    v_permlane32_swap_b32 v178, v179
    v_add_f32 v178, v178, v179
    ds_write_b32 v156, v178
    s_waitcnt lgkmcnt(0)
    s_barrier
    s_cmp_lg_u32 s28, 0
    s_cbranch_scc1 L_cs_S0
    ds_read_b32 v162, v156 offset:0
    ds_read_b32 v164, v156 offset:512
    ds_read_b32 v166, v156 offset:1024
    ds_read_b32 v168, v156 offset:1536
    ds_read_b32 v170, v156 offset:2048
    ds_read_b32 v172, v156 offset:2560
    ds_read_b32 v174, v156 offset:3072
    ds_read_b32 v176, v156 offset:3584
    v_mov_b32 v183, s6
    v_mov_b32 v185, s6
    v_lshlrev_b32 v156, 4, v1
    s_waitcnt lgkmcnt(0)
    v_pk_add_f32 v[162:163], v[162:163], v[170:171]
    v_pk_add_f32 v[164:165], v[164:165], v[172:173]
    v_pk_add_f32 v[166:167], v[166:167], v[174:175]
    v_pk_add_f32 v[168:169], v[168:169], v[176:177]
    v_pk_add_f32 v[162:163], v[162:163], v[166:167]
    v_pk_add_f32 v[164:165], v[164:165], v[168:169]
    v_add_f32 v182, v162, v164
    v_add_f32 v184, v163, v165
    buffer_store_dwordx4 v[182:185], v156, s[20:23], s42 offen sc1
L_cs_S0:
    s_add_u32 s69, s69, 1
    v_and_b32 v251, 15, v1
    v_lshlrev_b32 v251, 8, v251
    v_add_u32 v251, 0xeb2000, v251
    v_bfe_u32 v240, v1, 4, 1
    v_lshlrev_b32 v240, 2, v240
    v_xor_b32 v240, v141, v240
    v_lshlrev_b32 v240, 4, v240
    v_lshl_add_u32 v240, v140, 10, v240
    v_add_u32 v241, 7168, v240
    v_lshrrev_b32 v242, 4, v1
    s_and_b32 s31, s28, 1
    s_lshl_b32 s31, s31, 2
    v_or_b32 v242, s31, v242
    v_xor_b32 v242, v141, v242
    v_lshlrev_b32 v242, 4, v242
    v_lshl_add_u32 v242, v140, 10, v242
    s_lshr_b32 s31, s37, 2
    s_lshl_b32 s31, s31, 7
    s_lshl_b32 s52, s28, 16
    s_add_u32 s52, s52, s31
    s_lshl_b32 s53, s28, 13
    s_lshl_b32 s54, s36, 2
    s_and_b32 s55, s37, 3
    s_add_u32 s54, s54, s55
    s_lshl_b32 s54, s54, 16
    s_add_u32 s54, s54, s53
    s_add_u32 s54, s54, s31
    s_lshl_b32 s55, s28, 10
    s_add_u32 m0, s55, 148480
    s_nop 0
    buffer_load_dwordx4 v242, s[12:15], s54 offen lds
    v_mov_b32 v8, v232
    v_mov_b32 v9, v233
    v_mov_b32 v10, v234
    v_mov_b32 v11, v235
    v_mov_b32 v12, v236
    v_mov_b32 v13, v237
    v_mov_b32 v14, v238
    s_mul_i32 s32, s28, 8704
    s_add_u32 s32, s32, 65536
    v_lshl_add_u32 v4, v1, 3, s32
    v_and_b32 v6, 15, v1
    v_lshrrev_b32 v7, 4, v1
    v_mul_u32_u24 v5, 544, v6
    v_lshl_add_u32 v5, v7, 4, v5
    v_add_u32 v5, s32, v5
    v_lshlrev_b32 v14, 16, v14
    s_mov_b32 s40, 0x3fb8aa3b
    v_mul_f32 v15, s40, v14
    v_fma_f32 v16, v14, s40, -v15
    v_mov_b32 v17, 0x32a57060
    v_fmac_f32 v16, v14, v17
    v_exp_f32 v15, v15
    v_mul_f32 v16, 0x3f317218, v16
    v_fma_f32 v15, v15, v16, v15
    v_cvt_pk_bf16_f32 v15, v15, v15
    v_lshlrev_b32 v15, 16, v15
    v_lshlrev_b32 v16, 16, v8
    v_lshlrev_b32 v17, 16, v9
    v_and_b32 v18, 0xffff0000, v8
    v_and_b32 v19, 0xffff0000, v9
    v_lshlrev_b32 v20, 16, v10
    v_lshlrev_b32 v21, 16, v11
    v_and_b32 v22, 0xffff0000, v10
    v_and_b32 v23, 0xffff0000, v11
    v_lshlrev_b32 v24, 16, v12
    v_lshlrev_b32 v25, 16, v13
    v_and_b32 v26, 0xffff0000, v12
    v_and_b32 v27, 0xffff0000, v13
    v_mul_f32 v16, v15, v16
    v_mul_f32 v17, v15, v17
    v_mul_f32 v18, v15, v18
    v_mul_f32 v19, v15, v19
    v_mul_f32 v20, v15, v20
    v_mul_f32 v21, v15, v21
    v_mul_f32 v22, v15, v22
    v_mul_f32 v23, v15, v23
    v_pk_mul_f32 v[8:9], v[24:25], v[20:21] op_sel_hi:[1,0]
    v_pk_mul_f32 v[10:11], v[26:27], v[22:23] op_sel_hi:[1,0]
    v_pk_fma_f32 v[28:29], v[24:25], v[20:21], v[8:9] op_sel:[1,1,0] op_sel_hi:[0,1,1] neg_lo:[1,0,0]
    v_pk_fma_f32 v[30:31], v[26:27], v[22:23], v[10:11] op_sel:[1,1,0] op_sel_hi:[0,1,1] neg_lo:[1,0,0]
    v_mul_f32 v20, 0x3fb8aa3b, v16
    v_mul_f32 v21, 0x3e22f983, v17
    v_mul_f32 v22, 0x3fb8aa3b, v18
    v_mul_f32 v23, 0x3e22f983, v19
    v_exp_f32 v20, v20
    v_fract_f32 v21, v21
    v_exp_f32 v22, v22
    v_fract_f32 v23, v23
    v_cos_f32 v32, v21
    v_sin_f32 v33, v21
    v_cos_f32 v34, v23
    v_sin_f32 v35, v23
    v_pk_mul_f32 v[32:33], v[32:33], v[20:21] op_sel_hi:[1,0]
    v_pk_mul_f32 v[34:35], v[34:35], v[22:23] op_sel_hi:[1,0]
    v_mul_f32 v20, 0x4138aa3b, v16
    v_mul_f32 v21, 0xbfa2f983, v17
    v_mul_f32 v22, 0x4138aa3b, v18
    v_mul_f32 v23, 0xbfa2f983, v19
    v_exp_f32 v20, v20
    v_fract_f32 v21, v21
    v_exp_f32 v22, v22
    v_fract_f32 v23, v23
    v_cos_f32 v36, v21
    v_sin_f32 v37, v21
    v_cos_f32 v38, v23
    v_sin_f32 v39, v23
    v_pk_mul_f32 v[36:37], v[36:37], v[20:21] op_sel_hi:[1,0]
    v_pk_mul_f32 v[38:39], v[38:39], v[22:23] op_sel_hi:[1,0]
    v_mul_f32 v20, 0x4338aa3b, v16
    v_mul_f32 v21, 0x41a2f983, v17
    v_mul_f32 v22, 0x4338aa3b, v18
    v_mul_f32 v23, 0x41a2f983, v19
    v_exp_f32 v20, v20
    v_fract_f32 v21, v21
    v_exp_f32 v22, v22
    v_fract_f32 v23, v23
    v_cos_f32 v40, v21
    v_sin_f32 v41, v21
    v_cos_f32 v42, v23
    v_sin_f32 v43, v23
    v_pk_mul_f32 v[40:41], v[40:41], v[20:21] op_sel_hi:[1,0]
    v_pk_mul_f32 v[42:43], v[42:43], v[22:23] op_sel_hi:[1,0]
    s_mov_b32 m0, s53
    s_add_u32 s53, s53, 2048
    buffer_load_dwordx4 v240, s[60:63], s52 offen lds
    buffer_load_dwordx4 v241, s[60:63], s52 offen offset:1024 lds
    s_add_u32 s52, s52, 16384
    s_getpc_b64 s[44:45]
L_kg_pc:
    s_add_u32 s44, s44, L_kg_chain-L_kg_pc
    s_addc_u32 s45, s45, 0
    s_branch L_kg_go
.p2align 3
L_kg_chain:
    v_cvt_pk_bf16_f32 v12, v44, v45
    v_cvt_pk_bf16_f32 v13, v46, v47
    v_cvt_pk_bf16_f32 v14, v48, v49
    v_cvt_pk_bf16_f32 v15, v50, v51
    v_pk_mul_f32 v[8:9], v[44:45], v[52:53] op_sel_hi:[1,0]
    v_pk_mul_f32 v[10:11], v[46:47], v[54:55] op_sel_hi:[1,0]
    v_pk_mul_f32 v[68:69], v[48:49], v[52:53] op_sel_hi:[1,0]
    v_pk_mul_f32 v[70:71], v[50:51], v[54:55] op_sel_hi:[1,0]
    ds_write_b64 v56, v[12:13] offset:0
    ds_write_b64 v56, v[14:15] offset:544
    v_pk_fma_f32 v[44:45], v[44:45], v[52:53], v[8:9] op_sel:[1,1,0] op_sel_hi:[0,1,1] neg_lo:[1,0,0]
    v_pk_fma_f32 v[46:47], v[46:47], v[54:55], v[10:11] op_sel:[1,1,0] op_sel_hi:[0,1,1] neg_lo:[1,0,0]
    v_pk_fma_f32 v[48:49], v[48:49], v[52:53], v[68:69] op_sel:[1,1,0] op_sel_hi:[0,1,1] neg_lo:[1,0,0]
    v_pk_fma_f32 v[50:51], v[50:51], v[54:55], v[70:71] op_sel:[1,1,0] op_sel_hi:[0,1,1] neg_lo:[1,0,0]
    v_cvt_pk_bf16_f32 v72, v44, v45
    v_cvt_pk_bf16_f32 v73, v46, v47
    v_cvt_pk_bf16_f32 v74, v48, v49
    v_cvt_pk_bf16_f32 v75, v50, v51
    v_pk_mul_f32 v[8:9], v[44:45], v[52:53] op_sel_hi:[1,0]
    v_pk_mul_f32 v[10:11], v[46:47], v[54:55] op_sel_hi:[1,0]
    v_pk_mul_f32 v[68:69], v[48:49], v[52:53] op_sel_hi:[1,0]
    v_pk_mul_f32 v[70:71], v[50:51], v[54:55] op_sel_hi:[1,0]
    ds_write_b64 v56, v[72:73] offset:1088
    ds_write_b64 v56, v[74:75] offset:1632
    s_sub_u32 s33, s33, 1
    s_cmp_lg_u32 s33, 0
    v_pk_fma_f32 v[44:45], v[44:45], v[52:53], v[8:9] op_sel:[1,1,0] op_sel_hi:[0,1,1] neg_lo:[1,0,0]
    v_pk_fma_f32 v[46:47], v[46:47], v[54:55], v[10:11] op_sel:[1,1,0] op_sel_hi:[0,1,1] neg_lo:[1,0,0]
    v_pk_fma_f32 v[48:49], v[48:49], v[52:53], v[68:69] op_sel:[1,1,0] op_sel_hi:[0,1,1] neg_lo:[1,0,0]
    v_pk_fma_f32 v[50:51], v[50:51], v[54:55], v[70:71] op_sel:[1,1,0] op_sel_hi:[0,1,1] neg_lo:[1,0,0]
    v_add_u32 v56, 2176, v56
    s_cbranch_scc1 L_kg_chain
    s_setpc_b64 s[46:47]
L_kg_go:
    v_mov_b32 v44, 1.0
    v_mov_b32 v45, 0
    v_mov_b32 v46, 1.0
    v_mov_b32 v47, 0
    v_pk_mov_b32 v[48:49], v[36:37], v[36:37] op_sel:[0,1]
    v_pk_mov_b32 v[50:51], v[38:39], v[38:39] op_sel:[0,1]
    v_pk_mul_f32 v[8:9], v[36:37], v[36:37] op_sel_hi:[1,0]
    v_pk_mul_f32 v[10:11], v[38:39], v[38:39] op_sel_hi:[1,0]
    v_pk_fma_f32 v[52:53], v[36:37], v[36:37], v[8:9] op_sel:[1,1,0] op_sel_hi:[0,1,1] neg_lo:[1,0,0]
    v_pk_fma_f32 v[54:55], v[38:39], v[38:39], v[10:11] op_sel:[1,1,0] op_sel_hi:[0,1,1] neg_lo:[1,0,0]
    v_add_u32 v56, 0, v4
    s_movk_i32 s33, 4
    s_swappc_b64 s[46:47], s[44:45]
    s_cmp_lg_u32 s28, 6
    s_cbranch_scc1 L_kg_h1
    buffer_load_dword v250, v251, s[20:23], 0 offen sc1
L_kg_h1:
    s_mov_b32 m0, s53
    s_add_u32 s53, s53, 2048
    buffer_load_dwordx4 v240, s[60:63], s52 offen lds
    buffer_load_dwordx4 v241, s[60:63], s52 offen offset:1024 lds
    s_add_u32 s52, s52, 16384
    ds_read_b128 v[80:83], v5 offset:0
    ds_read_b128 v[84:87], v5 offset:64
    ds_read_b128 v[88:91], v5 offset:128
    ds_read_b128 v[92:95], v5 offset:192
    ds_read_b128 v[96:99], v5 offset:256
    ds_read_b128 v[100:103], v5 offset:320
    ds_read_b128 v[104:107], v5 offset:384
    ds_read_b128 v[108:111], v5 offset:448
    v_pk_mov_b32 v[44:45], v[28:29], v[28:29] op_sel:[0,1]
    v_pk_mov_b32 v[46:47], v[30:31], v[30:31] op_sel:[0,1]
    v_pk_mul_f32 v[8:9], v[28:29], v[40:41] op_sel_hi:[1,0]
    v_pk_mul_f32 v[10:11], v[30:31], v[42:43] op_sel_hi:[1,0]
    v_pk_fma_f32 v[28:29], v[28:29], v[40:41], v[8:9] op_sel:[1,1,0] op_sel_hi:[0,1,1] neg_lo:[1,0,0]
    v_pk_fma_f32 v[30:31], v[30:31], v[42:43], v[10:11] op_sel:[1,1,0] op_sel_hi:[0,1,1] neg_lo:[1,0,0]
    v_pk_mov_b32 v[48:49], v[28:29], v[28:29] op_sel:[0,1]
    v_pk_mov_b32 v[50:51], v[30:31], v[30:31] op_sel:[0,1]
    v_pk_mov_b32 v[52:53], v[32:33], v[32:33] op_sel:[0,1]
    v_pk_mov_b32 v[54:55], v[34:35], v[34:35] op_sel:[0,1]
    v_pk_mul_f32 v[8:9], v[32:33], v[32:33] op_sel_hi:[1,0]
    v_pk_mul_f32 v[10:11], v[34:35], v[34:35] op_sel_hi:[1,0]
    v_pk_fma_f32 v[60:61], v[32:33], v[32:33], v[8:9] op_sel:[1,1,0] op_sel_hi:[0,1,1] neg_lo:[1,0,0]
    v_pk_fma_f32 v[62:63], v[34:35], v[34:35], v[10:11] op_sel:[1,1,0] op_sel_hi:[0,1,1] neg_lo:[1,0,0]
    v_pk_mul_f32 v[68:69], v[28:29], v[40:41] op_sel_hi:[1,0]
    v_pk_mul_f32 v[70:71], v[30:31], v[42:43] op_sel_hi:[1,0]
    v_pk_fma_f32 v[28:29], v[28:29], v[40:41], v[68:69] op_sel:[1,1,0] op_sel_hi:[0,1,1] neg_lo:[1,0,0]
    v_pk_fma_f32 v[30:31], v[30:31], v[42:43], v[70:71] op_sel:[1,1,0] op_sel_hi:[0,1,1] neg_lo:[1,0,0]
    v_pk_mul_f32 v[8:9], v[60:61], v[60:61] op_sel_hi:[1,0]
    v_pk_mul_f32 v[10:11], v[62:63], v[62:63] op_sel_hi:[1,0]
    v_pk_fma_f32 v[64:65], v[60:61], v[60:61], v[8:9] op_sel:[1,1,0] op_sel_hi:[0,1,1] neg_lo:[1,0,0]
    v_pk_fma_f32 v[66:67], v[62:63], v[62:63], v[10:11] op_sel:[1,1,0] op_sel_hi:[0,1,1] neg_lo:[1,0,0]
    v_add_u32 v56, 0, v4
    s_movk_i32 s33, 4
    s_swappc_b64 s[46:47], s[44:45]
    ds_read_b128 v[112:115], v5 offset:0
    ds_read_b128 v[116:119], v5 offset:64
    ds_read_b128 v[120:123], v5 offset:128
    ds_read_b128 v[124:127], v5 offset:192
    ds_read_b128 v[128:131], v5 offset:256
    ds_read_b128 v[132:135], v5 offset:320
    ds_read_b128 v[136:139], v5 offset:384
    ds_read_b128 v[140:143], v5 offset:448
    s_cmp_lg_u32 s28, 6
    s_cbranch_scc1 L_kg_h2
    s_waitcnt vmcnt(0)
    s_mov_b32 s57, 0
    s_mov_b64 exec, 0xffff
L_ic_K:
    v_cmp_ne_u32 vcc, s6, v250
    s_cbranch_vccz L_io_K
    s_add_u32 s57, s57, 1
    s_cmp_gt_u32 s57, 200000
    s_cbranch_scc1 L_io_K
    s_sleep 8
    buffer_load_dword v250, v251, s[20:23], 0 offen sc1
    s_waitcnt vmcnt(0)
    s_branch L_ic_K
L_io_K:
    s_mov_b64 exec, -1
    s_and_b32 s30, s2, 15
    s_lshl_b32 s30, s30, 8
    s_add_u32 s31, s30, 0xeb0000
    v_mov_b32 v250, 1
    v_mov_b32 v251, 0
    s_mov_b64 exec, 1
    buffer_atomic_add v250, v251, s[20:23], s31 offen sc0 sc1
    s_mov_b64 exec, -1
L_kg_h2:
    s_mov_b32 m0, s53
    s_add_u32 s53, s53, 2048
    buffer_load_dwordx4 v240, s[60:63], s52 offen lds
    buffer_load_dwordx4 v241, s[60:63], s52 offen offset:1024 lds
    s_add_u32 s52, s52, 16384
    v_pk_mov_b32 v[52:53], v[40:41], v[40:41] op_sel:[0,1]
    v_pk_mov_b32 v[54:55], v[42:43], v[42:43] op_sel:[0,1]
    v_pk_mul_f32 v[8:9], v[28:29], v[60:61] op_sel_hi:[1,0]
    v_pk_mul_f32 v[10:11], v[30:31], v[62:63] op_sel_hi:[1,0]
    v_pk_fma_f32 v[44:45], v[28:29], v[60:61], v[8:9] op_sel:[1,1,0] op_sel_hi:[0,1,1] neg_lo:[1,0,0]
    v_pk_fma_f32 v[46:47], v[30:31], v[62:63], v[10:11] op_sel:[1,1,0] op_sel_hi:[0,1,1] neg_lo:[1,0,0]
    v_pk_mul_f32 v[68:69], v[44:45], v[64:65] op_sel_hi:[1,0]
    v_pk_mul_f32 v[70:71], v[46:47], v[66:67] op_sel_hi:[1,0]
    v_pk_fma_f32 v[48:49], v[44:45], v[64:65], v[68:69] op_sel:[1,1,0] op_sel_hi:[0,1,1] neg_lo:[1,0,0]
    v_pk_fma_f32 v[50:51], v[46:47], v[66:67], v[70:71] op_sel:[1,1,0] op_sel_hi:[0,1,1] neg_lo:[1,0,0]
    v_add_u32 v56, 0, v4
    s_movk_i32 s33, 1
    s_swappc_b64 s[46:47], s[44:45]
    v_pk_mov_b32 v[44:45], v[28:29], v[28:29] op_sel:[0,1]
    v_pk_mov_b32 v[46:47], v[30:31], v[30:31] op_sel:[0,1]
    v_pk_mul_f32 v[68:69], v[28:29], v[64:65] op_sel_hi:[1,0]
    v_pk_mul_f32 v[70:71], v[30:31], v[66:67] op_sel_hi:[1,0]
    v_pk_fma_f32 v[48:49], v[28:29], v[64:65], v[68:69] op_sel:[1,1,0] op_sel_hi:[0,1,1] neg_lo:[1,0,0]
    v_pk_fma_f32 v[50:51], v[30:31], v[66:67], v[70:71] op_sel:[1,1,0] op_sel_hi:[0,1,1] neg_lo:[1,0,0]
    v_add_u32 v56, 2176, v4
    s_movk_i32 s33, 3
    s_swappc_b64 s[46:47], s[44:45]
    ds_read_b128 v[144:147], v5 offset:0
    ds_read_b128 v[148:151], v5 offset:64
    ds_read_b128 v[152:155], v5 offset:128
    ds_read_b128 v[156:159], v5 offset:192
    ds_read_b128 v[160:163], v5 offset:256
    ds_read_b128 v[164:167], v5 offset:320
    ds_read_b128 v[168:171], v5 offset:384
    ds_read_b128 v[172:175], v5 offset:448
    s_cmp_lg_u32 s28, 6
    s_cbranch_scc1 L_kg_h3
    s_waitcnt vmcnt(0)
    v_readfirstlane_b32 s31, v250
    s_nop 0
    s_cmp_lg_u32 s31, 15
    s_cbranch_scc1 L_kg_h3
    v_mov_b32 v250, 1
    v_lshlrev_b32 v251, 8, v1
    s_mov_b32 s30, 0xec0000
    buffer_atomic_add v250, v251, s[20:23], s30 offen sc1
    s_mov_b64 exec, -1
L_kg_h3:
    s_mov_b32 m0, s53
    s_add_u32 s53, s53, 2048
    buffer_load_dwordx4 v240, s[60:63], s52 offen lds
    buffer_load_dwordx4 v241, s[60:63], s52 offen offset:1024 lds
    s_add_u32 s52, s52, 16384
    v_pk_mul_f32 v[68:69], v[44:45], v[40:41] op_sel_hi:[1,0]
    v_pk_mul_f32 v[70:71], v[46:47], v[42:43] op_sel_hi:[1,0]
    v_pk_fma_f32 v[48:49], v[44:45], v[40:41], v[68:69] op_sel:[1,1,0] op_sel_hi:[0,1,1] neg_lo:[1,0,0]
    v_pk_fma_f32 v[50:51], v[46:47], v[42:43], v[70:71] op_sel:[1,1,0] op_sel_hi:[0,1,1] neg_lo:[1,0,0]
    v_pk_mul_f32 v[8:9], v[40:41], v[40:41] op_sel_hi:[1,0]
    v_pk_mul_f32 v[10:11], v[42:43], v[42:43] op_sel_hi:[1,0]
    v_pk_fma_f32 v[52:53], v[40:41], v[40:41], v[8:9] op_sel:[1,1,0] op_sel_hi:[0,1,1] neg_lo:[1,0,0]
    v_pk_fma_f32 v[54:55], v[42:43], v[42:43], v[10:11] op_sel:[1,1,0] op_sel_hi:[0,1,1] neg_lo:[1,0,0]
    v_add_u32 v56, 0, v4
    s_movk_i32 s33, 3
    s_swappc_b64 s[46:47], s[44:45]
    ds_read_b128 v[176:179], v5 offset:0
    ds_read_b128 v[180:183], v5 offset:64
    ds_read_b128 v[184:187], v5 offset:128
    ds_read_b128 v[188:191], v5 offset:192
    ds_read_b128 v[192:195], v5 offset:256
    ds_read_b128 v[196:199], v5 offset:320
    ds_read_b128 v[200:203], v5 offset:384
    ds_read_b128 v[204:207], v5 offset:448
    s_waitcnt lgkmcnt(8)
    v_mfma_f32_16x16x32_bf16 v[208:211], v[112:115], v[80:83], 0
    v_mfma_f32_16x16x32_bf16 v[208:211], v[116:119], v[84:87], v[208:211]
    v_mfma_f32_16x16x32_bf16 v[208:211], v[120:123], v[88:91], v[208:211]
    v_mfma_f32_16x16x32_bf16 v[208:211], v[124:127], v[92:95], v[208:211]
    v_mfma_f32_16x16x32_bf16 v[208:211], v[128:131], v[96:99], v[208:211]
    v_mfma_f32_16x16x32_bf16 v[208:211], v[132:135], v[100:103], v[208:211]
    v_mfma_f32_16x16x32_bf16 v[208:211], v[136:139], v[104:107], v[208:211]
    v_mfma_f32_16x16x32_bf16 v[208:211], v[140:143], v[108:111], v[208:211]
    v_mfma_f32_16x16x32_bf16 v[212:215], v[144:147], v[80:83], 0
    v_mfma_f32_16x16x32_bf16 v[212:215], v[148:151], v[84:87], v[212:215]
    v_mfma_f32_16x16x32_bf16 v[212:215], v[152:155], v[88:91], v[212:215]
    v_mfma_f32_16x16x32_bf16 v[212:215], v[156:159], v[92:95], v[212:215]
    v_mfma_f32_16x16x32_bf16 v[212:215], v[160:163], v[96:99], v[212:215]
    v_mfma_f32_16x16x32_bf16 v[212:215], v[164:167], v[100:103], v[212:215]
    v_mfma_f32_16x16x32_bf16 v[212:215], v[168:171], v[104:107], v[212:215]
    v_mfma_f32_16x16x32_bf16 v[212:215], v[172:175], v[108:111], v[212:215]
    s_waitcnt lgkmcnt(0)
    v_mfma_f32_16x16x32_bf16 v[216:219], v[176:179], v[80:83], 0
    v_mfma_f32_16x16x32_bf16 v[216:219], v[180:183], v[84:87], v[216:219]
    v_mfma_f32_16x16x32_bf16 v[216:219], v[184:187], v[88:91], v[216:219]
    v_mfma_f32_16x16x32_bf16 v[216:219], v[188:191], v[92:95], v[216:219]
    v_mfma_f32_16x16x32_bf16 v[216:219], v[192:195], v[96:99], v[216:219]
    v_mfma_f32_16x16x32_bf16 v[216:219], v[196:199], v[100:103], v[216:219]
    v_mfma_f32_16x16x32_bf16 v[216:219], v[200:203], v[104:107], v[216:219]
    v_mfma_f32_16x16x32_bf16 v[216:219], v[204:207], v[108:111], v[216:219]
    s_add_u32 s33, s32, 16
    v_lshl_add_u32 v16, v6, 4, s33
    v_lshrrev_b32 v17, 1, v7
    v_and_b32 v18, 1, v7
    v_lshl_add_u32 v19, v7, 2, v16
    v_lshlrev_b32 v20, 9, v7
    v_subrev_u32 v20, 512, v20
    v_cmp_eq_u32 vcc, 0, v7
    s_nop 1
    v_cndmask_b32 v20, v20, 4, vcc
    v_add_u32 v20, v20, v16
    v_mul_u32_u24 v21, 1022, v17
    v_sub_u32 v21, 1024, v21
    v_mul_u32_u24 v21, v21, v18
    v_lshl_add_u32 v21, v17, 11, v21
    v_add_u32 v21, v21, v16
    v_cvt_pk_bf16_f32 v24, v208, v209
    v_cvt_pk_bf16_f32 v25, v210, v211
    ds_write_b16 v19, v24 offset:0
    ds_write_b16_d16_hi v19, v24 offset:256
    ds_write_b16 v19, v25 offset:2
    ds_write_b16_d16_hi v19, v25 offset:258
    v_cvt_pk_bf16_f32 v26, v212, v213
    v_cvt_pk_bf16_f32 v27, v214, v215
    ds_write_b16 v20, v26 offset:512
    ds_write_b16_d16_hi v20, v26 offset:520
    ds_write_b16 v20, v27 offset:768
    ds_write_b16_d16_hi v20, v27 offset:776
    v_cvt_pk_bf16_f32 v28, v216, v217
    v_cvt_pk_bf16_f32 v29, v218, v219
    ds_write_b16 v21, v28 offset:2048
    ds_write_b16_d16_hi v21, v28 offset:2304
    ds_write_b16 v21, v29 offset:2560
    ds_write_b16_d16_hi v21, v29 offset:2816
    v_sub_u32 v16, 63, v1
    v_lshl_add_u32 v17, v16, 4, s33
    v_lshrrev_b32 v18, 5, v16
    v_lshlrev_b32 v18, 1, v18
    v_sub_u32 v19, v17, v18
    v_add_u32 v20, v17, v18
    v_and_b32 v18, 1, v16
    v_lshl_add_u32 v21, v18, 4, v17
    v_lshlrev_b32 v22, 4, v1
    s_mul_i32 s34, s58, 8448
    s_add_u32 s34, s34, 0xa80000
    v_mov_b32 v23, 0
    v_mov_b32 v30, s32
    ds_write_b16 v30, v23 offset:14
    v_cmp_ge_u32 vcc, 32, v16
    s_nop 1
    v_cndmask_b32 v23, 0, 2, vcc
    v_sub_u32 v23, v17, v23
    ds_read_u16 v48, v20 offset:14
    ds_read_u16 v49, v17 offset:12
    ds_read_u16 v50, v19 offset:10
    ds_read_u16 v51, v17 offset:8
    ds_read_u16 v52, v20 offset:6
    ds_read_u16 v53, v17 offset:4
    ds_read_u16 v54, v19 offset:2
    ds_read_u16 v55, v17 offset:0
    ds_read_u16 v65, v23 offset:0
    ds_read_u16 v56, v17 offset:1024
    ds_read_u16 v57, v17 offset:1032
    ds_read_u16 v58, v17 offset:1040
    ds_read_u16 v59, v17 offset:2048
    ds_read_u16 v60, v17 offset:2064
    ds_read_u16 v61, v21 offset:2048
    ds_read_u16 v62, v17 offset:3072
    ds_read_u16 v63, v17 offset:3088
    ds_read_u16 v64, v21 offset:3072
    s_add_u32 s35, s34, 4224
    s_waitcnt vmcnt(0) lgkmcnt(9)
    v_lshl_or_b32 v32, v49, 16, v48
    v_lshl_or_b32 v33, v51, 16, v50
    v_lshl_or_b32 v34, v53, 16, v52
    v_lshl_or_b32 v35, v55, 16, v54
    buffer_store_dwordx4 v[32:35], v22, s[20:23], s34 offen offset:3072 sc1
    v_alignbit_b32 v72, v33, v32, 16
    v_alignbit_b32 v73, v34, v33, 16
    v_alignbit_b32 v74, v35, v34, 16
    v_alignbit_b32 v75, v65, v35, 16
    buffer_store_dwordx4 v[72:75], v22, s[20:23], s35 offen offset:3072 sc1
    s_waitcnt lgkmcnt(6)
    v_lshl_or_b32 v36, v58, 16, v58
    v_lshl_or_b32 v37, v57, 16, v57
    v_lshl_or_b32 v38, v56, 16, v57
    v_lshl_or_b32 v39, v56, 16, v56
    buffer_store_dwordx4 v[36:39], v22, s[20:23], s34 offen offset:2048 sc1
    v_alignbit_b32 v76, v37, v36, 16
    v_alignbit_b32 v77, v38, v37, 16
    v_alignbit_b32 v78, v39, v38, 16
    v_alignbit_b32 v79, v56, v39, 16
    buffer_store_dwordx4 v[76:79], v22, s[20:23], s35 offen offset:2048 sc1
    s_waitcnt lgkmcnt(0)
    v_lshl_or_b32 v40, v60, 16, v60
    v_lshl_or_b32 v41, v61, 16, v60
    v_lshl_or_b32 v42, v59, 16, v59
    v_lshl_or_b32 v43, v59, 16, v59
    buffer_store_dwordx4 v[40:43], v22, s[20:23], s34 offen offset:1024 sc1
    v_alignbit_b32 v80, v41, v40, 16
    v_alignbit_b32 v81, v42, v41, 16
    v_alignbit_b32 v82, v43, v42, 16
    v_alignbit_b32 v83, v59, v43, 16
    buffer_store_dwordx4 v[80:83], v22, s[20:23], s35 offen offset:1024 sc1
    v_lshl_or_b32 v44, v63, 16, v63
    v_lshl_or_b32 v45, v64, 16, v63
    v_lshl_or_b32 v46, v62, 16, v62
    v_lshl_or_b32 v47, v62, 16, v62
    buffer_store_dwordx4 v[44:47], v22, s[20:23], s34 offen offset:0 sc1
    v_alignbit_b32 v84, v45, v44, 16
    v_alignbit_b32 v85, v46, v45, 16
    v_alignbit_b32 v86, v47, v46, 16
    v_alignbit_b32 v87, v62, v47, 16
    buffer_store_dwordx4 v[84:87], v22, s[20:23], s35 offen offset:0 sc1
    s_add_u32 s35, s35, 4096
    s_add_u32 s34, s34, 4096
    v_mov_b32 v92, 0
    v_mov_b32 v93, 0
    v_mov_b32 v94, 0
    v_mov_b32 v95, 0
    s_mov_b64 exec, 0xff
    buffer_store_dwordx4 v[92:95], v22, s[20:23], s34 offen sc1
    buffer_store_dwordx4 v[92:95], v22, s[20:23], s35 offen sc1
    s_mov_b64 exec, -1
    s_branch L_B
L_stat1:
    v_lshrrev_b32 v156, 3, v1
    v_and_b32 v157, 7, v1
    v_bfe_u32 v158, v1, 4, 1
    v_lshlrev_b32 v158, 2, v158
    v_xor_b32 v157, v157, v158
    v_lshlrev_b32 v157, 4, v157
    v_mul_u32_u24 v150, 4096, v156
    v_add_u32 v150, v150, v157
    v_add_u32 v151, 31744, v150
    v_add_u32 v152, 63488, v150
    v_add_u32 v153, 95232, v150
    v_lshrrev_b32 v156, 5, v1
    v_bfe_u32 v157, v1, 2, 2
    v_lshl_add_u32 v154, v156, 3, v157
    v_lshlrev_b32 v154, 7, v154
    v_lshl_add_u32 v154, v158, 3, v154
    v_and_b32 v158, 3, v1
    v_lshl_add_u32 v154, v158, 3, v154
    v_lshrrev_b32 v157, 1, v157
    v_lshl_add_u32 v154, v157, 6, v154
    s_lshl_b32 s40, s28, 12
    v_add_u32 v154, s40, v154
    v_xor_b32 v155, 64, v154
    s_mov_b32 m0, s40
    s_lshl_b32 s43, s39, 20
    s_lshl_b32 s33, s28, 17
    s_add_u32 s43, s43, s33
    s_lshl_b32 s33, s38, 7
    s_add_u32 s43, s43, s33
    s_add_u32 s43, s43, 0x880000
    s_lshl_b32 s42, s29, 10
    s_add_u32 s42, s42, 0x850000
    s_cmp_lg_u32 s28, 6
    s_cbranch_scc1 L_gw_S1
    s_and_b32 s30, s2, 63
    s_lshl_b32 s30, s30, 8
    s_add_u32 s30, s30, 0xec0000
    s_mov_b32 s31, 0
    s_lshl_b32 s32, s69, 4
    v_mov_b32 v3, 0
    v_mov_b32 v2, 0
    s_mov_b64 exec, 1
    buffer_atomic_add v2, v3, s[20:23], s30 offen sc0 sc1
L_gp_S1:
    v_mov_b32 v31, 0
    s_sleep 1
    buffer_atomic_add v31, v3, s[20:23], s30 offen sc0 sc1
    s_add_u32 s31, s31, 1
    s_waitcnt vmcnt(1)
    v_cmp_gt_u32 vcc, s32, v2
    s_cbranch_vccz L_gd_S1
    v_mov_b32 v2, 0
    s_sleep 1
    buffer_atomic_add v2, v3, s[20:23], s30 offen sc0 sc1
    s_cmp_gt_u32 s31, 200000
    s_cbranch_scc1 L_gd_S1
    s_waitcnt vmcnt(1)
    v_cmp_gt_u32 vcc, s32, v31
    s_cbranch_vccnz L_gp_S1
L_gd_S1:
    s_mov_b64 exec, -1
L_gw_S1:
    s_barrier
    buffer_load_dwordx4 v150, s[20:23], s43 offen offset:0 sc1 lds
    buffer_load_dwordx4 v151, s[20:23], s43 offen offset:1024 sc1 lds
    buffer_load_dwordx4 v152, s[20:23], s43 offen offset:2048 sc1 lds
    buffer_load_dwordx4 v153, s[20:23], s43 offen offset:3072 sc1 lds
    s_waitcnt vmcnt(0)
    ds_read_b64_tr_b16 v[162:163], v154 offset:0
    ds_read_b64_tr_b16 v[164:165], v154 offset:512
    ds_read_b64_tr_b16 v[166:167], v154 offset:2048
    ds_read_b64_tr_b16 v[168:169], v154 offset:2560
    ds_read_b64_tr_b16 v[170:171], v155 offset:0
    ds_read_b64_tr_b16 v[172:173], v155 offset:512
    ds_read_b64_tr_b16 v[174:175], v155 offset:2048
    ds_read_b64_tr_b16 v[176:177], v155 offset:2560
    v_mov_b32 v178, 0
    v_mov_b32 v179, 0
    v_mov_b32 v180, 0
    v_mov_b32 v181, 0
    s_mov_b32 s48, 0x3f803f80
    s_lshl_b32 s40, s28, 9
    s_add_u32 s40, s40, 137216
    v_lshl_add_u32 v156, v1, 2, s40
    s_waitcnt lgkmcnt(0)
    v_dot2c_f32_bf16 v178, s48, v162
    v_dot2c_f32_bf16 v180, v162, v162
    v_dot2c_f32_bf16 v179, s48, v170
    v_dot2c_f32_bf16 v181, v170, v170
    v_dot2c_f32_bf16 v178, s48, v163
    v_dot2c_f32_bf16 v180, v163, v163
    v_dot2c_f32_bf16 v179, s48, v171
    v_dot2c_f32_bf16 v181, v171, v171
    v_dot2c_f32_bf16 v178, s48, v164
    v_dot2c_f32_bf16 v180, v164, v164
    v_dot2c_f32_bf16 v179, s48, v172
    v_dot2c_f32_bf16 v181, v172, v172
    v_dot2c_f32_bf16 v178, s48, v165
    v_dot2c_f32_bf16 v180, v165, v165
    v_dot2c_f32_bf16 v179, s48, v173
    v_dot2c_f32_bf16 v181, v173, v173
    v_dot2c_f32_bf16 v178, s48, v166
    v_dot2c_f32_bf16 v180, v166, v166
    v_dot2c_f32_bf16 v179, s48, v174
    v_dot2c_f32_bf16 v181, v174, v174
    v_dot2c_f32_bf16 v178, s48, v167
    v_dot2c_f32_bf16 v180, v167, v167
    v_dot2c_f32_bf16 v179, s48, v175
    v_dot2c_f32_bf16 v181, v175, v175
    v_dot2c_f32_bf16 v178, s48, v168
    v_dot2c_f32_bf16 v180, v168, v168
    v_dot2c_f32_bf16 v179, s48, v176
    v_dot2c_f32_bf16 v181, v176, v176
    v_dot2c_f32_bf16 v178, s48, v169
    v_dot2c_f32_bf16 v180, v169, v169
    v_dot2c_f32_bf16 v179, s48, v177
    v_dot2c_f32_bf16 v181, v177, v177
    s_nop 1
    v_permlane32_swap_b32 v178, v179
    v_permlane32_swap_b32 v180, v181
    v_add_f32 v178, v178, v179
    ds_write_b32 v156, v178
    v_add_f32 v180, v180, v181
    ds_write_b32 v156, v180 offset:256
    s_waitcnt lgkmcnt(0)
    s_barrier
    s_cmp_lg_u32 s28, 0
    s_cbranch_scc1 L_cs_S1
    ds_read2st64_b32 v[162:163], v156 offset0:0 offset1:1
    ds_read2st64_b32 v[164:165], v156 offset0:2 offset1:3
    ds_read2st64_b32 v[166:167], v156 offset0:4 offset1:5
    ds_read2st64_b32 v[168:169], v156 offset0:6 offset1:7
    ds_read2st64_b32 v[170:171], v156 offset0:8 offset1:9
    ds_read2st64_b32 v[172:173], v156 offset0:10 offset1:11
    ds_read2st64_b32 v[174:175], v156 offset0:12 offset1:13
    ds_read2st64_b32 v[176:177], v156 offset0:14 offset1:15
    v_mov_b32 v183, s6
    v_mov_b32 v185, s6
    v_lshlrev_b32 v156, 4, v1
    s_waitcnt lgkmcnt(0)
    v_pk_add_f32 v[162:163], v[162:163], v[170:171]
    v_pk_add_f32 v[164:165], v[164:165], v[172:173]
    v_pk_add_f32 v[166:167], v[166:167], v[174:175]
    v_pk_add_f32 v[168:169], v[168:169], v[176:177]
    v_pk_add_f32 v[162:163], v[162:163], v[166:167]
    v_pk_add_f32 v[164:165], v[164:165], v[168:169]
    v_add_f32 v182, v162, v164
    v_add_f32 v184, v163, v165
    buffer_store_dwordx4 v[182:185], v156, s[20:23], s42 offen sc1
L_cs_S1:
    s_cmp_lt_u32 s28, 4
    s_cbranch_scc1 L_A_end
    s_lshl_b32 s29, s36, 2
    s_and_b32 s38, s37, 3
    s_add_u32 s29, s29, s38
    s_lshr_b32 s30, s37, 2
    s_and_b32 s41, s28, 3
    s_lshr_b32 s42, s41, 1
    s_and_b32 s43, s41, 1
    v_lshrrev_b32 v8, 3, v1
    v_and_b32 v9, 7, v1
    v_bfe_u32 v10, v1, 4, 1
    v_lshlrev_b32 v10, 2, v10
    v_xor_b32 v10, v9, v10
    v_lshlrev_b32 v10, 4, v10
    v_lshl_add_u32 v12, v8, 10, v10
    v_add_u32 v13, 7168, v12
    v_add_u32 v14, 14336, v12
    v_add_u32 v15, 21504, v12
    s_lshl_b32 s50, s41, 17
    s_lshl_b32 s49, s30, 7
    s_add_u32 s50, s50, s49
    s_lshl_b32 s51, s41, 14
    s_mov_b32 s52, 0
L_shb_1:
    s_add_u32 s44, s52, s38
    s_and_b32 s44, s44, 3
    s_lshl_b32 s45, s44, 15
    s_add_u32 s45, s45, s50
    s_lshl_b32 s44, s44, 12
    s_add_u32 m0, s44, s51
    s_add_u32 s52, s52, 1
    buffer_load_dwordx4 v12, s[60:63], s45 offen offset:0 lds
    buffer_load_dwordx4 v13, s[60:63], s45 offen offset:1024 lds
    buffer_load_dwordx4 v14, s[60:63], s45 offen offset:2048 lds
    buffer_load_dwordx4 v15, s[60:63], s45 offen offset:3072 lds
    s_cmp_lt_u32 s52, 4
    s_cbranch_scc1 L_shb_1
    s_lshl_b32 s44, s41, 11
    s_add_u32 m0, s44, 148480
    s_cmp_lg_u32 s68, 0
    s_cbranch_scc1 L_shb1_1
    v_lshrrev_b32 v11, 4, v1
    v_xor_b32 v11, v9, v11
    v_lshlrev_b32 v11, 4, v11
    v_lshl_add_u32 v16, v8, 10, v11
    v_xor_b32 v17, 64, v16
    v_add_u32 v17, 7168, v17
    s_lshl_b32 s48, s29, 16
    s_lshl_b32 s44, s41, 14
    s_add_u32 s48, s48, s44
    s_add_u32 s48, s48, s49
    buffer_load_dwordx4 v16, s[12:15], s48 offen lds
    buffer_load_dwordx4 v17, s[12:15], s48 offen offset:1024 lds
    s_branch L_shb2_1
L_shb1_1:
    v_lshl_add_u32 v16, v8, 12, v10
    v_add_u32 v17, 31744, v16
    s_lshl_b32 s48, s30, 18
    s_lshl_b32 s44, s41, 16
    s_add_u32 s48, s48, s44
    s_lshl_b32 s44, s29, 7
    s_add_u32 s48, s48, s44
    s_add_u32 s48, s48, 0x880000
    buffer_load_dwordx4 v16, s[20:23], s48 offen sc1 lds
    buffer_load_dwordx4 v17, s[20:23], s48 offen offset:1024 sc1 lds
L_shb2_1:
    s_branch L_A_end
L_Amain:
    s_cmp_lg_u32 s68, 0
    s_cbranch_scc1 L_nopf
    s_getpc_b64 s[38:39]
L_pc:
    s_sub_u32 s38, s38, L_pc-interleave_layers__linear_attn_block__ssm_conv_s4__prompt_kernel
    s_subb_u32 s39, s39, 0
    s_cmp_ge_u32 s37, 16
    s_cbranch_scc1 L_nopf
    s_lshr_b32 s40, s37, 1
    s_lshl_b32 s40, s40, 12
    v_lshl_add_u32 v250, v0, 4, s40
    global_load_dwordx4 v[252:255], v250, s[38:39]
L_nopf:
    s_lshr_b32 s41, s28, 1
    s_and_b32 s42, s28, 1
    v_lshrrev_b32 v3, 5, v1
    v_bfe_u32 v4, v1, 2, 2
    v_lshl_add_u32 v5, v3, 3, v4
    v_lshlrev_b32 v5, 8, v5
    v_bfe_u32 v6, v1, 4, 1
    v_lshl_add_u32 v5, v6, 5, v5
    v_and_b32 v6, 3, v1
    v_lshl_add_u32 v5, v6, 3, v5
    v_xor_b32 v6, s42, v4
    v_lshl_add_u32 v8, v6, 6, v5
    v_add_u32 v8, 65536, v8
    v_xor_b32 v9, 128, v8
    v_and_b32 v2, 31, v1
    s_mov_b32 s45, 0
    s_mov_b32 s48, 0x3f803f80
    s_mov_b32 s46, 0x358637bd
    s_mov_b32 s47, 0x358637bd
    v_mov_b32 v64, 0
    v_mov_b32 v65, 0
    v_mov_b32 v66, 0
    v_mov_b32 v67, 0
    v_mov_b32 v68, 0
    v_mov_b32 v69, 0
    v_mov_b32 v70, 0
    v_mov_b32 v71, 0
    v_mov_b32 v72, 0
    v_mov_b32 v73, 0
    v_mov_b32 v74, 0
    v_mov_b32 v75, 0
    v_mov_b32 v76, 0
    v_mov_b32 v77, 0
    v_mov_b32 v78, 0
    v_mov_b32 v79, 0
    v_mov_b32 v80, 0
    v_mov_b32 v81, 0
    v_mov_b32 v82, 0
    v_mov_b32 v83, 0
    v_mov_b32 v84, 0
    v_mov_b32 v85, 0
    v_mov_b32 v86, 0
    v_mov_b32 v87, 0
    v_mov_b32 v88, 0
    v_mov_b32 v89, 0
    v_mov_b32 v90, 0
    v_mov_b32 v91, 0
    v_mov_b32 v92, 0
    v_mov_b32 v93, 0
    v_mov_b32 v94, 0
    v_mov_b32 v95, 0
    v_mov_b32 v96, 0
    v_mov_b32 v97, 0
    v_mov_b32 v98, 0
    v_mov_b32 v99, 0
    v_mov_b32 v100, 0
    v_mov_b32 v101, 0
    v_mov_b32 v102, 0
    v_mov_b32 v103, 0
    v_mov_b32 v104, 0
    v_mov_b32 v105, 0
    v_mov_b32 v106, 0
    v_mov_b32 v107, 0
    v_mov_b32 v108, 0
    v_mov_b32 v109, 0
    v_mov_b32 v110, 0
    v_mov_b32 v111, 0
    v_mov_b32 v112, 0
    v_mov_b32 v113, 0
    v_mov_b32 v114, 0
    v_mov_b32 v115, 0
    v_mov_b32 v116, 0
    v_mov_b32 v117, 0
    v_mov_b32 v118, 0
    v_mov_b32 v119, 0
    v_mov_b32 v120, 0
    v_mov_b32 v121, 0
    v_mov_b32 v122, 0
    v_mov_b32 v123, 0
    v_mov_b32 v124, 0
    v_mov_b32 v125, 0
    v_mov_b32 v126, 0
    v_mov_b32 v127, 0
    s_lshl_b32 s43, s41, 8
    s_add_u32 s43, s43, 131072
    s_lshl_b32 s44, s42, 7
    s_add_u32 s44, s44, 132608
    v_lshlrev_b32 v12, 4, v3
    v_lshlrev_b32 v13, 2, v2
    v_mov_b32 v14, s30
    v_cmp_le_u32 vcc, 4, v14
    s_nop 1
    v_cndmask_b32 v10, v12, v13, vcc
    v_cndmask_b32 v11, v13, v12, vcc
    v_add_u32 v10, s43, v10
    v_add_u32 v11, s44, v11
    s_cmp_lg_u32 s68, 0
    s_cbranch_scc1 L_Amain1
    v_bfe_u32 v7, v1, 1, 3
    v_xor_b32 v7, v7, v3
    v_lshlrev_b32 v7, 4, v7
    v_lshl_add_u32 v7, v2, 7, v7
    s_lshl_b32 s43, s41, 13
    v_add_u32 v4, s43, v7
    v_xor_b32 v5, 32, v4
    v_xor_b32 v6, 64, v4
    v_xor_b32 v7, 96, v4
    s_waitcnt lgkmcnt(0)
    s_load_dword s6, s[20:21], s7
    s_waitcnt lgkmcnt(0)
    s_add_u32 s6, s6, 8
    s_cmp_ge_u32 s30, 4
    s_cbranch_scc1 L_mq_A0
    s_barrier
    ds_read_b128 v[128:131], v4 offset:0
    ds_read_b64_tr_b16 v[136:137], v8 offset:0
    ds_read_b64_tr_b16 v[138:139], v8 offset:1024
    ds_read_b64_tr_b16 v[140:141], v9 offset:0
    ds_read_b64_tr_b16 v[142:143], v9 offset:1024
    ds_read_b128 v[132:135], v4 offset:4096
    ds_read_b128 v[144:147], v5 offset:0
    ds_read_b64_tr_b16 v[152:153], v8 offset:4096
    ds_read_b64_tr_b16 v[154:155], v8 offset:5120
    ds_read_b64_tr_b16 v[156:157], v9 offset:4096
    ds_read_b64_tr_b16 v[158:159], v9 offset:5120
    ds_read_b128 v[148:151], v5 offset:4096
.p2align 3
L_loop_kv_A0:
    s_waitcnt lgkmcnt(6)
    v_mfma_f32_32x32x16_bf16 v[64:79], v[128:131], v[136:139], v[64:79]
    ds_read_b128 v[160:163], v6 offset:0
    ds_read_b64_tr_b16 v[168:169], v8 offset:8192
    ds_read_b64_tr_b16 v[170:171], v8 offset:9216
    v_mfma_f32_32x32x16_bf16 v[80:95], v[128:131], v[140:143], v[80:95]
    ds_read_b64_tr_b16 v[172:173], v9 offset:8192
    ds_read_b64_tr_b16 v[174:175], v9 offset:9216
    v_mfma_f32_32x32x16_bf16 v[96:111], v[132:135], v[136:139], v[96:111]
    ds_read_b128 v[164:167], v6 offset:4096
    v_mfma_f32_32x32x16_bf16 v[112:127], v[132:135], v[140:143], v[112:127]
    s_waitcnt lgkmcnt(6)
    v_mfma_f32_32x32x16_bf16 v[64:79], v[144:147], v[152:155], v[64:79]
    ds_read_b128 v[176:179], v7 offset:0
    ds_read_b64_tr_b16 v[184:185], v8 offset:12288
    ds_read_b64_tr_b16 v[186:187], v8 offset:13312
    v_mfma_f32_32x32x16_bf16 v[80:95], v[144:147], v[156:159], v[80:95]
    ds_read_b64_tr_b16 v[188:189], v9 offset:12288
    ds_read_b64_tr_b16 v[190:191], v9 offset:13312
    v_mfma_f32_32x32x16_bf16 v[96:111], v[148:151], v[152:155], v[96:111]
    ds_read_b128 v[180:183], v7 offset:4096
    v_mfma_f32_32x32x16_bf16 v[112:127], v[148:151], v[156:159], v[112:127]
    s_waitcnt lgkmcnt(6)
    v_mfma_f32_32x32x16_bf16 v[64:79], v[160:163], v[168:171], v[64:79]
    s_waitcnt lgkmcnt(0)
    s_barrier
    ds_read_b128 v[128:131], v4 offset:16384
    ds_read_b64_tr_b16 v[136:137], v8 offset:16384
    ds_read_b64_tr_b16 v[138:139], v8 offset:17408
    v_mfma_f32_32x32x16_bf16 v[80:95], v[160:163], v[172:175], v[80:95]
    ds_read_b64_tr_b16 v[140:141], v9 offset:16384
    ds_read_b64_tr_b16 v[142:143], v9 offset:17408
    v_mfma_f32_32x32x16_bf16 v[96:111], v[164:167], v[168:171], v[96:111]
    ds_read_b128 v[132:135], v4 offset:20480
    v_mfma_f32_32x32x16_bf16 v[112:127], v[164:167], v[172:175], v[112:127]
    s_waitcnt lgkmcnt(6)
    v_mfma_f32_32x32x16_bf16 v[64:79], v[176:179], v[184:187], v[64:79]
    ds_read_b128 v[144:147], v5 offset:16384
    ds_read_b64_tr_b16 v[152:153], v8 offset:20480
    ds_read_b64_tr_b16 v[154:155], v8 offset:21504
    v_mfma_f32_32x32x16_bf16 v[80:95], v[176:179], v[188:191], v[80:95]
    ds_read_b64_tr_b16 v[156:157], v9 offset:20480
    ds_read_b64_tr_b16 v[158:159], v9 offset:21504
    v_mfma_f32_32x32x16_bf16 v[96:111], v[180:183], v[184:187], v[96:111]
    ds_read_b128 v[148:151], v5 offset:20480
    v_mfma_f32_32x32x16_bf16 v[112:127], v[180:183], v[188:191], v[112:127]
    s_waitcnt lgkmcnt(6)
    v_mfma_f32_32x32x16_bf16 v[64:79], v[128:131], v[136:139], v[64:79]
    ds_read_b128 v[160:163], v6 offset:16384
    ds_read_b64_tr_b16 v[168:169], v8 offset:24576
    ds_read_b64_tr_b16 v[170:171], v8 offset:25600
    v_mfma_f32_32x32x16_bf16 v[80:95], v[128:131], v[140:143], v[80:95]
    ds_read_b64_tr_b16 v[172:173], v9 offset:24576
    ds_read_b64_tr_b16 v[174:175], v9 offset:25600
    v_mfma_f32_32x32x16_bf16 v[96:111], v[132:135], v[136:139], v[96:111]
    ds_read_b128 v[164:167], v6 offset:20480
    v_mfma_f32_32x32x16_bf16 v[112:127], v[132:135], v[140:143], v[112:127]
    s_waitcnt lgkmcnt(6)
    v_mfma_f32_32x32x16_bf16 v[64:79], v[144:147], v[152:155], v[64:79]
    ds_read_b128 v[176:179], v7 offset:16384
    ds_read_b64_tr_b16 v[184:185], v8 offset:28672
    ds_read_b64_tr_b16 v[186:187], v8 offset:29696
    v_mfma_f32_32x32x16_bf16 v[80:95], v[144:147], v[156:159], v[80:95]
    ds_read_b64_tr_b16 v[188:189], v9 offset:28672
    ds_read_b64_tr_b16 v[190:191], v9 offset:29696
    v_mfma_f32_32x32x16_bf16 v[96:111], v[148:151], v[152:155], v[96:111]
    ds_read_b128 v[180:183], v7 offset:20480
    v_mfma_f32_32x32x16_bf16 v[112:127], v[148:151], v[156:159], v[112:127]
    s_waitcnt lgkmcnt(6)
    v_mfma_f32_32x32x16_bf16 v[64:79], v[160:163], v[168:171], v[64:79]
    s_waitcnt lgkmcnt(0)
    s_barrier
    ds_read_b128 v[128:131], v4 offset:32768
    ds_read_b64_tr_b16 v[136:137], v8 offset:32768
    ds_read_b64_tr_b16 v[138:139], v8 offset:33792
    v_mfma_f32_32x32x16_bf16 v[80:95], v[160:163], v[172:175], v[80:95]
    ds_read_b64_tr_b16 v[140:141], v9 offset:32768
    ds_read_b64_tr_b16 v[142:143], v9 offset:33792
    v_mfma_f32_32x32x16_bf16 v[96:111], v[164:167], v[168:171], v[96:111]
    ds_read_b128 v[132:135], v4 offset:36864
    v_mfma_f32_32x32x16_bf16 v[112:127], v[164:167], v[172:175], v[112:127]
    s_waitcnt lgkmcnt(6)
    v_mfma_f32_32x32x16_bf16 v[64:79], v[176:179], v[184:187], v[64:79]
    ds_read_b128 v[144:147], v5 offset:32768
    ds_read_b64_tr_b16 v[152:153], v8 offset:36864
    ds_read_b64_tr_b16 v[154:155], v8 offset:37888
    v_mfma_f32_32x32x16_bf16 v[80:95], v[176:179], v[188:191], v[80:95]
    ds_read_b64_tr_b16 v[156:157], v9 offset:36864
    ds_read_b64_tr_b16 v[158:159], v9 offset:37888
    v_mfma_f32_32x32x16_bf16 v[96:111], v[180:183], v[184:187], v[96:111]
    ds_read_b128 v[148:151], v5 offset:36864
    v_mfma_f32_32x32x16_bf16 v[112:127], v[180:183], v[188:191], v[112:127]
    s_waitcnt lgkmcnt(6)
    v_mfma_f32_32x32x16_bf16 v[64:79], v[128:131], v[136:139], v[64:79]
    ds_read_b128 v[160:163], v6 offset:32768
    ds_read_b64_tr_b16 v[168:169], v8 offset:40960
    ds_read_b64_tr_b16 v[170:171], v8 offset:41984
    v_mfma_f32_32x32x16_bf16 v[80:95], v[128:131], v[140:143], v[80:95]
    ds_read_b64_tr_b16 v[172:173], v9 offset:40960
    ds_read_b64_tr_b16 v[174:175], v9 offset:41984
    v_mfma_f32_32x32x16_bf16 v[96:111], v[132:135], v[136:139], v[96:111]
    ds_read_b128 v[164:167], v6 offset:36864
    v_mfma_f32_32x32x16_bf16 v[112:127], v[132:135], v[140:143], v[112:127]
    s_waitcnt lgkmcnt(6)
    v_mfma_f32_32x32x16_bf16 v[64:79], v[144:147], v[152:155], v[64:79]
    ds_read_b128 v[176:179], v7 offset:32768
    ds_read_b64_tr_b16 v[184:185], v8 offset:45056
    ds_read_b64_tr_b16 v[186:187], v8 offset:46080
    v_mfma_f32_32x32x16_bf16 v[80:95], v[144:147], v[156:159], v[80:95]
    ds_read_b64_tr_b16 v[188:189], v9 offset:45056
    ds_read_b64_tr_b16 v[190:191], v9 offset:46080
    v_mfma_f32_32x32x16_bf16 v[96:111], v[148:151], v[152:155], v[96:111]
    ds_read_b128 v[180:183], v7 offset:36864
    v_mfma_f32_32x32x16_bf16 v[112:127], v[148:151], v[156:159], v[112:127]
    s_waitcnt lgkmcnt(6)
    v_mfma_f32_32x32x16_bf16 v[64:79], v[160:163], v[168:171], v[64:79]
    s_waitcnt lgkmcnt(0)
    s_barrier
    ds_read_b128 v[128:131], v4 offset:49152
    ds_read_b64_tr_b16 v[136:137], v8 offset:49152
    ds_read_b64_tr_b16 v[138:139], v8 offset:50176
    v_mfma_f32_32x32x16_bf16 v[80:95], v[160:163], v[172:175], v[80:95]
    ds_read_b64_tr_b16 v[140:141], v9 offset:49152
    ds_read_b64_tr_b16 v[142:143], v9 offset:50176
    v_mfma_f32_32x32x16_bf16 v[96:111], v[164:167], v[168:171], v[96:111]
    ds_read_b128 v[132:135], v4 offset:53248
    v_mfma_f32_32x32x16_bf16 v[112:127], v[164:167], v[172:175], v[112:127]
    s_waitcnt lgkmcnt(6)
    v_mfma_f32_32x32x16_bf16 v[64:79], v[176:179], v[184:187], v[64:79]
    ds_read_b128 v[144:147], v5 offset:49152
    ds_read_b64_tr_b16 v[152:153], v8 offset:53248
    ds_read_b64_tr_b16 v[154:155], v8 offset:54272
    v_mfma_f32_32x32x16_bf16 v[80:95], v[176:179], v[188:191], v[80:95]
    ds_read_b64_tr_b16 v[156:157], v9 offset:53248
    ds_read_b64_tr_b16 v[158:159], v9 offset:54272
    v_mfma_f32_32x32x16_bf16 v[96:111], v[180:183], v[184:187], v[96:111]
    ds_read_b128 v[148:151], v5 offset:53248
    v_mfma_f32_32x32x16_bf16 v[112:127], v[180:183], v[188:191], v[112:127]
    s_waitcnt lgkmcnt(6)
    v_mfma_f32_32x32x16_bf16 v[64:79], v[128:131], v[136:139], v[64:79]
    ds_read_b128 v[160:163], v6 offset:49152
    ds_read_b64_tr_b16 v[168:169], v8 offset:57344
    ds_read_b64_tr_b16 v[170:171], v8 offset:58368
    v_mfma_f32_32x32x16_bf16 v[80:95], v[128:131], v[140:143], v[80:95]
    ds_read_b64_tr_b16 v[172:173], v9 offset:57344
    ds_read_b64_tr_b16 v[174:175], v9 offset:58368
    v_mfma_f32_32x32x16_bf16 v[96:111], v[132:135], v[136:139], v[96:111]
    ds_read_b128 v[164:167], v6 offset:53248
    v_mfma_f32_32x32x16_bf16 v[112:127], v[132:135], v[140:143], v[112:127]
    s_waitcnt lgkmcnt(6)
    v_mfma_f32_32x32x16_bf16 v[64:79], v[144:147], v[152:155], v[64:79]
    ds_read_b128 v[176:179], v7 offset:49152
    ds_read_b64_tr_b16 v[184:185], v8 offset:61440
    ds_read_b64_tr_b16 v[186:187], v8 offset:62464
    v_mfma_f32_32x32x16_bf16 v[80:95], v[144:147], v[156:159], v[80:95]
    ds_read_b64_tr_b16 v[188:189], v9 offset:61440
    ds_read_b64_tr_b16 v[190:191], v9 offset:62464
    v_mfma_f32_32x32x16_bf16 v[96:111], v[148:151], v[152:155], v[96:111]
    ds_read_b128 v[180:183], v7 offset:53248
    v_mfma_f32_32x32x16_bf16 v[112:127], v[148:151], v[156:159], v[112:127]
    s_cmp_eq_u32 s45, 1
    s_cbranch_scc1 L_last_kv
    s_mov_b32 s45, 1
    s_waitcnt lgkmcnt(6)
    v_mfma_f32_32x32x16_bf16 v[64:79], v[160:163], v[168:171], v[64:79]
    s_waitcnt lgkmcnt(0)
    s_barrier
    ds_read_b128 v[128:131], v4 offset:0
    ds_read_b64_tr_b16 v[136:137], v8 offset:0
    ds_read_b64_tr_b16 v[138:139], v8 offset:1024
    v_mfma_f32_32x32x16_bf16 v[80:95], v[160:163], v[172:175], v[80:95]
    ds_read_b64_tr_b16 v[140:141], v9 offset:0
    ds_read_b64_tr_b16 v[142:143], v9 offset:1024
    v_mfma_f32_32x32x16_bf16 v[96:111], v[164:167], v[168:171], v[96:111]
    ds_read_b128 v[132:135], v4 offset:4096
    v_mfma_f32_32x32x16_bf16 v[112:127], v[164:167], v[172:175], v[112:127]
    s_waitcnt lgkmcnt(6)
    v_mfma_f32_32x32x16_bf16 v[64:79], v[176:179], v[184:187], v[64:79]
    ds_read_b128 v[144:147], v5 offset:0
    ds_read_b64_tr_b16 v[152:153], v8 offset:4096
    ds_read_b64_tr_b16 v[154:155], v8 offset:5120
    v_mfma_f32_32x32x16_bf16 v[80:95], v[176:179], v[188:191], v[80:95]
    ds_read_b64_tr_b16 v[156:157], v9 offset:4096
    ds_read_b64_tr_b16 v[158:159], v9 offset:5120
    v_mfma_f32_32x32x16_bf16 v[96:111], v[180:183], v[184:187], v[96:111]
    ds_read_b128 v[148:151], v5 offset:4096
    v_mfma_f32_32x32x16_bf16 v[112:127], v[180:183], v[188:191], v[112:127]
    s_branch L_loop_kv_A0
L_mq_A0:
    s_barrier
    ds_read_b128 v[128:131], v4 offset:0
    ds_read_b64_tr_b16 v[136:137], v8 offset:0
    ds_read_b64_tr_b16 v[138:139], v8 offset:1024
    ds_read_b64_tr_b16 v[140:141], v9 offset:0
    ds_read_b64_tr_b16 v[142:143], v9 offset:1024
    ds_read_b128 v[132:135], v4 offset:4096
    ds_read_b128 v[144:147], v5 offset:0
    ds_read_b64_tr_b16 v[152:153], v8 offset:4096
    ds_read_b64_tr_b16 v[154:155], v8 offset:5120
    ds_read_b64_tr_b16 v[156:157], v9 offset:4096
    ds_read_b64_tr_b16 v[158:159], v9 offset:5120
    ds_read_b128 v[148:151], v5 offset:4096
.p2align 3
L_loop_q_A0:
    s_waitcnt lgkmcnt(6)
    v_mfma_f32_32x32x16_bf16 v[64:79], v[136:139], v[128:131], v[64:79]
    ds_read_b128 v[160:163], v6 offset:0
    ds_read_b64_tr_b16 v[168:169], v8 offset:8192
    ds_read_b64_tr_b16 v[170:171], v8 offset:9216
    v_mfma_f32_32x32x16_bf16 v[80:95], v[140:143], v[128:131], v[80:95]
    ds_read_b64_tr_b16 v[172:173], v9 offset:8192
    ds_read_b64_tr_b16 v[174:175], v9 offset:9216
    v_mfma_f32_32x32x16_bf16 v[96:111], v[136:139], v[132:135], v[96:111]
    ds_read_b128 v[164:167], v6 offset:4096
    v_mfma_f32_32x32x16_bf16 v[112:127], v[140:143], v[132:135], v[112:127]
    s_waitcnt lgkmcnt(6)
    v_mfma_f32_32x32x16_bf16 v[64:79], v[152:155], v[144:147], v[64:79]
    ds_read_b128 v[176:179], v7 offset:0
    ds_read_b64_tr_b16 v[184:185], v8 offset:12288
    ds_read_b64_tr_b16 v[186:187], v8 offset:13312
    v_mfma_f32_32x32x16_bf16 v[80:95], v[156:159], v[144:147], v[80:95]
    ds_read_b64_tr_b16 v[188:189], v9 offset:12288
    ds_read_b64_tr_b16 v[190:191], v9 offset:13312
    v_mfma_f32_32x32x16_bf16 v[96:111], v[152:155], v[148:151], v[96:111]
    ds_read_b128 v[180:183], v7 offset:4096
    v_mfma_f32_32x32x16_bf16 v[112:127], v[156:159], v[148:151], v[112:127]
    s_waitcnt lgkmcnt(6)
    v_mfma_f32_32x32x16_bf16 v[64:79], v[168:171], v[160:163], v[64:79]
    s_waitcnt lgkmcnt(0)
    s_barrier
    ds_read_b128 v[128:131], v4 offset:16384
    ds_read_b64_tr_b16 v[136:137], v8 offset:16384
    ds_read_b64_tr_b16 v[138:139], v8 offset:17408
    v_mfma_f32_32x32x16_bf16 v[80:95], v[172:175], v[160:163], v[80:95]
    ds_read_b64_tr_b16 v[140:141], v9 offset:16384
    ds_read_b64_tr_b16 v[142:143], v9 offset:17408
    v_mfma_f32_32x32x16_bf16 v[96:111], v[168:171], v[164:167], v[96:111]
    ds_read_b128 v[132:135], v4 offset:20480
    v_mfma_f32_32x32x16_bf16 v[112:127], v[172:175], v[164:167], v[112:127]
    s_waitcnt lgkmcnt(6)
    v_mfma_f32_32x32x16_bf16 v[64:79], v[184:187], v[176:179], v[64:79]
    ds_read_b128 v[144:147], v5 offset:16384
    ds_read_b64_tr_b16 v[152:153], v8 offset:20480
    ds_read_b64_tr_b16 v[154:155], v8 offset:21504
    v_mfma_f32_32x32x16_bf16 v[80:95], v[188:191], v[176:179], v[80:95]
    ds_read_b64_tr_b16 v[156:157], v9 offset:20480
    ds_read_b64_tr_b16 v[158:159], v9 offset:21504
    v_mfma_f32_32x32x16_bf16 v[96:111], v[184:187], v[180:183], v[96:111]
    ds_read_b128 v[148:151], v5 offset:20480
    v_mfma_f32_32x32x16_bf16 v[112:127], v[188:191], v[180:183], v[112:127]
    s_waitcnt lgkmcnt(6)
    v_mfma_f32_32x32x16_bf16 v[64:79], v[136:139], v[128:131], v[64:79]
    ds_read_b128 v[160:163], v6 offset:16384
    ds_read_b64_tr_b16 v[168:169], v8 offset:24576
    ds_read_b64_tr_b16 v[170:171], v8 offset:25600
    v_mfma_f32_32x32x16_bf16 v[80:95], v[140:143], v[128:131], v[80:95]
    ds_read_b64_tr_b16 v[172:173], v9 offset:24576
    ds_read_b64_tr_b16 v[174:175], v9 offset:25600
    v_mfma_f32_32x32x16_bf16 v[96:111], v[136:139], v[132:135], v[96:111]
    ds_read_b128 v[164:167], v6 offset:20480
    v_mfma_f32_32x32x16_bf16 v[112:127], v[140:143], v[132:135], v[112:127]
    s_waitcnt lgkmcnt(6)
    v_mfma_f32_32x32x16_bf16 v[64:79], v[152:155], v[144:147], v[64:79]
    ds_read_b128 v[176:179], v7 offset:16384
    ds_read_b64_tr_b16 v[184:185], v8 offset:28672
    ds_read_b64_tr_b16 v[186:187], v8 offset:29696
    v_mfma_f32_32x32x16_bf16 v[80:95], v[156:159], v[144:147], v[80:95]
    ds_read_b64_tr_b16 v[188:189], v9 offset:28672
    ds_read_b64_tr_b16 v[190:191], v9 offset:29696
    v_mfma_f32_32x32x16_bf16 v[96:111], v[152:155], v[148:151], v[96:111]
    ds_read_b128 v[180:183], v7 offset:20480
    v_mfma_f32_32x32x16_bf16 v[112:127], v[156:159], v[148:151], v[112:127]
    s_waitcnt lgkmcnt(6)
    v_mfma_f32_32x32x16_bf16 v[64:79], v[168:171], v[160:163], v[64:79]
    s_waitcnt lgkmcnt(0)
    s_barrier
    ds_read_b128 v[128:131], v4 offset:32768
    ds_read_b64_tr_b16 v[136:137], v8 offset:32768
    ds_read_b64_tr_b16 v[138:139], v8 offset:33792
    v_mfma_f32_32x32x16_bf16 v[80:95], v[172:175], v[160:163], v[80:95]
    ds_read_b64_tr_b16 v[140:141], v9 offset:32768
    ds_read_b64_tr_b16 v[142:143], v9 offset:33792
    v_mfma_f32_32x32x16_bf16 v[96:111], v[168:171], v[164:167], v[96:111]
    ds_read_b128 v[132:135], v4 offset:36864
    v_mfma_f32_32x32x16_bf16 v[112:127], v[172:175], v[164:167], v[112:127]
    s_waitcnt lgkmcnt(6)
    v_mfma_f32_32x32x16_bf16 v[64:79], v[184:187], v[176:179], v[64:79]
    ds_read_b128 v[144:147], v5 offset:32768
    ds_read_b64_tr_b16 v[152:153], v8 offset:36864
    ds_read_b64_tr_b16 v[154:155], v8 offset:37888
    v_mfma_f32_32x32x16_bf16 v[80:95], v[188:191], v[176:179], v[80:95]
    ds_read_b64_tr_b16 v[156:157], v9 offset:36864
    ds_read_b64_tr_b16 v[158:159], v9 offset:37888
    v_mfma_f32_32x32x16_bf16 v[96:111], v[184:187], v[180:183], v[96:111]
    ds_read_b128 v[148:151], v5 offset:36864
    v_mfma_f32_32x32x16_bf16 v[112:127], v[188:191], v[180:183], v[112:127]
    s_waitcnt lgkmcnt(6)
    v_mfma_f32_32x32x16_bf16 v[64:79], v[136:139], v[128:131], v[64:79]
    ds_read_b128 v[160:163], v6 offset:32768
    ds_read_b64_tr_b16 v[168:169], v8 offset:40960
    ds_read_b64_tr_b16 v[170:171], v8 offset:41984
    v_mfma_f32_32x32x16_bf16 v[80:95], v[140:143], v[128:131], v[80:95]
    ds_read_b64_tr_b16 v[172:173], v9 offset:40960
    ds_read_b64_tr_b16 v[174:175], v9 offset:41984
    v_mfma_f32_32x32x16_bf16 v[96:111], v[136:139], v[132:135], v[96:111]
    ds_read_b128 v[164:167], v6 offset:36864
    v_mfma_f32_32x32x16_bf16 v[112:127], v[140:143], v[132:135], v[112:127]
    s_waitcnt lgkmcnt(6)
    v_mfma_f32_32x32x16_bf16 v[64:79], v[152:155], v[144:147], v[64:79]
    ds_read_b128 v[176:179], v7 offset:32768
    ds_read_b64_tr_b16 v[184:185], v8 offset:45056
    ds_read_b64_tr_b16 v[186:187], v8 offset:46080
    v_mfma_f32_32x32x16_bf16 v[80:95], v[156:159], v[144:147], v[80:95]
    ds_read_b64_tr_b16 v[188:189], v9 offset:45056
    ds_read_b64_tr_b16 v[190:191], v9 offset:46080
    v_mfma_f32_32x32x16_bf16 v[96:111], v[152:155], v[148:151], v[96:111]
    ds_read_b128 v[180:183], v7 offset:36864
    v_mfma_f32_32x32x16_bf16 v[112:127], v[156:159], v[148:151], v[112:127]
    s_waitcnt lgkmcnt(6)
    v_mfma_f32_32x32x16_bf16 v[64:79], v[168:171], v[160:163], v[64:79]
    s_waitcnt lgkmcnt(0)
    s_barrier
    ds_read_b128 v[128:131], v4 offset:49152
    ds_read_b64_tr_b16 v[136:137], v8 offset:49152
    ds_read_b64_tr_b16 v[138:139], v8 offset:50176
    v_mfma_f32_32x32x16_bf16 v[80:95], v[172:175], v[160:163], v[80:95]
    ds_read_b64_tr_b16 v[140:141], v9 offset:49152
    ds_read_b64_tr_b16 v[142:143], v9 offset:50176
    v_mfma_f32_32x32x16_bf16 v[96:111], v[168:171], v[164:167], v[96:111]
    ds_read_b128 v[132:135], v4 offset:53248
    v_mfma_f32_32x32x16_bf16 v[112:127], v[172:175], v[164:167], v[112:127]
    s_waitcnt lgkmcnt(6)
    v_mfma_f32_32x32x16_bf16 v[64:79], v[184:187], v[176:179], v[64:79]
    ds_read_b128 v[144:147], v5 offset:49152
    ds_read_b64_tr_b16 v[152:153], v8 offset:53248
    ds_read_b64_tr_b16 v[154:155], v8 offset:54272
    v_mfma_f32_32x32x16_bf16 v[80:95], v[188:191], v[176:179], v[80:95]
    ds_read_b64_tr_b16 v[156:157], v9 offset:53248
    ds_read_b64_tr_b16 v[158:159], v9 offset:54272
    v_mfma_f32_32x32x16_bf16 v[96:111], v[184:187], v[180:183], v[96:111]
    ds_read_b128 v[148:151], v5 offset:53248
    v_mfma_f32_32x32x16_bf16 v[112:127], v[188:191], v[180:183], v[112:127]
    s_waitcnt lgkmcnt(6)
    v_mfma_f32_32x32x16_bf16 v[64:79], v[136:139], v[128:131], v[64:79]
    ds_read_b128 v[160:163], v6 offset:49152
    ds_read_b64_tr_b16 v[168:169], v8 offset:57344
    ds_read_b64_tr_b16 v[170:171], v8 offset:58368
    v_mfma_f32_32x32x16_bf16 v[80:95], v[140:143], v[128:131], v[80:95]
    ds_read_b64_tr_b16 v[172:173], v9 offset:57344
    ds_read_b64_tr_b16 v[174:175], v9 offset:58368
    v_mfma_f32_32x32x16_bf16 v[96:111], v[136:139], v[132:135], v[96:111]
    ds_read_b128 v[164:167], v6 offset:53248
    v_mfma_f32_32x32x16_bf16 v[112:127], v[140:143], v[132:135], v[112:127]
    s_waitcnt lgkmcnt(6)
    v_mfma_f32_32x32x16_bf16 v[64:79], v[152:155], v[144:147], v[64:79]
    ds_read_b128 v[176:179], v7 offset:49152
    ds_read_b64_tr_b16 v[184:185], v8 offset:61440
    ds_read_b64_tr_b16 v[186:187], v8 offset:62464
    v_mfma_f32_32x32x16_bf16 v[80:95], v[156:159], v[144:147], v[80:95]
    ds_read_b64_tr_b16 v[188:189], v9 offset:61440
    ds_read_b64_tr_b16 v[190:191], v9 offset:62464
    v_mfma_f32_32x32x16_bf16 v[96:111], v[152:155], v[148:151], v[96:111]
    ds_read_b128 v[180:183], v7 offset:53248
    v_mfma_f32_32x32x16_bf16 v[112:127], v[156:159], v[148:151], v[112:127]
    s_cmp_eq_u32 s45, 1
    s_cbranch_scc1 L_last_q
    s_mov_b32 s45, 1
    s_waitcnt lgkmcnt(6)
    v_mfma_f32_32x32x16_bf16 v[64:79], v[168:171], v[160:163], v[64:79]
    s_waitcnt lgkmcnt(0)
    s_barrier
    ds_read_b128 v[128:131], v4 offset:0
    ds_read_b64_tr_b16 v[136:137], v8 offset:0
    ds_read_b64_tr_b16 v[138:139], v8 offset:1024
    v_mfma_f32_32x32x16_bf16 v[80:95], v[172:175], v[160:163], v[80:95]
    ds_read_b64_tr_b16 v[140:141], v9 offset:0
    ds_read_b64_tr_b16 v[142:143], v9 offset:1024
    v_mfma_f32_32x32x16_bf16 v[96:111], v[168:171], v[164:167], v[96:111]
    ds_read_b128 v[132:135], v4 offset:4096
    v_mfma_f32_32x32x16_bf16 v[112:127], v[172:175], v[164:167], v[112:127]
    s_waitcnt lgkmcnt(6)
    v_mfma_f32_32x32x16_bf16 v[64:79], v[184:187], v[176:179], v[64:79]
    ds_read_b128 v[144:147], v5 offset:0
    ds_read_b64_tr_b16 v[152:153], v8 offset:4096
    ds_read_b64_tr_b16 v[154:155], v8 offset:5120
    v_mfma_f32_32x32x16_bf16 v[80:95], v[188:191], v[176:179], v[80:95]
    ds_read_b64_tr_b16 v[156:157], v9 offset:4096
    ds_read_b64_tr_b16 v[158:159], v9 offset:5120
    v_mfma_f32_32x32x16_bf16 v[96:111], v[184:187], v[180:183], v[96:111]
    ds_read_b128 v[148:151], v5 offset:4096
    v_mfma_f32_32x32x16_bf16 v[112:127], v[188:191], v[180:183], v[112:127]
    s_branch L_loop_q_A0
L_Amain1:
    s_lshl_b32 s43, s41, 1
    v_xor_b32 v6, s43, v4
    v_lshl_add_u32 v4, v6, 6, v5
    v_xor_b32 v5, 64, v4
    s_mov_b32 s56, s30
    v_mov_b32 v14, v3
    s_cmp_lg_u32 s28, 0
    s_cbranch_scc1 L_gw_A1
    s_and_b32 s30, s2, 63
    s_lshl_b32 s30, s30, 8
    s_add_u32 s30, s30, 0xec0000
    s_mov_b32 s31, 0
    s_lshl_b32 s32, s69, 4
    v_mov_b32 v3, 0
    v_mov_b32 v2, 0
    s_mov_b64 exec, 1
    buffer_atomic_add v2, v3, s[20:23], s30 offen sc0 sc1
L_gp_A1:
    v_mov_b32 v31, 0
    s_sleep 1
    buffer_atomic_add v31, v3, s[20:23], s30 offen sc0 sc1
    s_add_u32 s31, s31, 1
    s_waitcnt vmcnt(1)
    v_cmp_gt_u32 vcc, s32, v2
    s_cbranch_vccz L_gd_A1
    v_mov_b32 v2, 0
    s_sleep 1
    buffer_atomic_add v2, v3, s[20:23], s30 offen sc0 sc1
    s_cmp_gt_u32 s31, 200000
    s_cbranch_scc1 L_gd_A1
    s_waitcnt vmcnt(1)
    v_cmp_gt_u32 vcc, s32, v31
    s_cbranch_vccnz L_gp_A1
L_gd_A1:
    s_mov_b64 exec, -1
L_gw_A1:
    s_barrier
    s_mov_b32 s30, s56
    v_mov_b32 v3, v14
    s_cmp_ge_u32 s30, 4
    s_cbranch_scc1 L_mq_A1
    s_barrier
    ds_read_b64_tr_b16 v[128:129], v4 offset:0
    ds_read_b64_tr_b16 v[130:131], v4 offset:1024
    ds_read_b64_tr_b16 v[136:137], v8 offset:0
    ds_read_b64_tr_b16 v[138:139], v8 offset:1024
    ds_read_b64_tr_b16 v[140:141], v9 offset:0
    ds_read_b64_tr_b16 v[142:143], v9 offset:1024
    ds_read_b64_tr_b16 v[132:133], v5 offset:0
    ds_read_b64_tr_b16 v[134:135], v5 offset:1024
    ds_read_b64_tr_b16 v[144:145], v4 offset:4096
    ds_read_b64_tr_b16 v[146:147], v4 offset:5120
    ds_read_b64_tr_b16 v[152:153], v8 offset:4096
    ds_read_b64_tr_b16 v[154:155], v8 offset:5120
    ds_read_b64_tr_b16 v[156:157], v9 offset:4096
    ds_read_b64_tr_b16 v[158:159], v9 offset:5120
    ds_read_b64_tr_b16 v[148:149], v5 offset:4096
    ds_read_b64_tr_b16 v[150:151], v5 offset:5120
.p2align 3
L_loop_kv_A1:
    s_waitcnt lgkmcnt(8)
    v_mfma_f32_32x32x16_bf16 v[64:79], v[128:131], v[136:139], v[64:79]
    ds_read_b64_tr_b16 v[160:161], v4 offset:8192
    ds_read_b64_tr_b16 v[162:163], v4 offset:9216
    ds_read_b64_tr_b16 v[168:169], v8 offset:8192
    v_mfma_f32_32x32x16_bf16 v[80:95], v[128:131], v[140:143], v[80:95]
    ds_read_b64_tr_b16 v[170:171], v8 offset:9216
    ds_read_b64_tr_b16 v[172:173], v9 offset:8192
    ds_read_b64_tr_b16 v[174:175], v9 offset:9216
    v_mfma_f32_32x32x16_bf16 v[96:111], v[132:135], v[136:139], v[96:111]
    ds_read_b64_tr_b16 v[164:165], v5 offset:8192
    ds_read_b64_tr_b16 v[166:167], v5 offset:9216
    v_mfma_f32_32x32x16_bf16 v[112:127], v[132:135], v[140:143], v[112:127]
    s_waitcnt lgkmcnt(8)
    v_mfma_f32_32x32x16_bf16 v[64:79], v[144:147], v[152:155], v[64:79]
    ds_read_b64_tr_b16 v[176:177], v4 offset:12288
    ds_read_b64_tr_b16 v[178:179], v4 offset:13312
    ds_read_b64_tr_b16 v[184:185], v8 offset:12288
    v_mfma_f32_32x32x16_bf16 v[80:95], v[144:147], v[156:159], v[80:95]
    ds_read_b64_tr_b16 v[186:187], v8 offset:13312
    ds_read_b64_tr_b16 v[188:189], v9 offset:12288
    ds_read_b64_tr_b16 v[190:191], v9 offset:13312
    v_mfma_f32_32x32x16_bf16 v[96:111], v[148:151], v[152:155], v[96:111]
    ds_read_b64_tr_b16 v[180:181], v5 offset:12288
    ds_read_b64_tr_b16 v[182:183], v5 offset:13312
    v_mfma_f32_32x32x16_bf16 v[112:127], v[148:151], v[156:159], v[112:127]
    s_waitcnt lgkmcnt(8)
    v_mfma_f32_32x32x16_bf16 v[64:79], v[160:163], v[168:171], v[64:79]
    s_waitcnt lgkmcnt(0)
    s_barrier
    ds_read_b64_tr_b16 v[128:129], v4 offset:16384
    ds_read_b64_tr_b16 v[130:131], v4 offset:17408
    ds_read_b64_tr_b16 v[136:137], v8 offset:16384
    v_mfma_f32_32x32x16_bf16 v[80:95], v[160:163], v[172:175], v[80:95]
    ds_read_b64_tr_b16 v[138:139], v8 offset:17408
    ds_read_b64_tr_b16 v[140:141], v9 offset:16384
    ds_read_b64_tr_b16 v[142:143], v9 offset:17408
    v_mfma_f32_32x32x16_bf16 v[96:111], v[164:167], v[168:171], v[96:111]
    ds_read_b64_tr_b16 v[132:133], v5 offset:16384
    ds_read_b64_tr_b16 v[134:135], v5 offset:17408
    v_mfma_f32_32x32x16_bf16 v[112:127], v[164:167], v[172:175], v[112:127]
    s_waitcnt lgkmcnt(8)
    v_mfma_f32_32x32x16_bf16 v[64:79], v[176:179], v[184:187], v[64:79]
    ds_read_b64_tr_b16 v[144:145], v4 offset:20480
    ds_read_b64_tr_b16 v[146:147], v4 offset:21504
    ds_read_b64_tr_b16 v[152:153], v8 offset:20480
    v_mfma_f32_32x32x16_bf16 v[80:95], v[176:179], v[188:191], v[80:95]
    ds_read_b64_tr_b16 v[154:155], v8 offset:21504
    ds_read_b64_tr_b16 v[156:157], v9 offset:20480
    ds_read_b64_tr_b16 v[158:159], v9 offset:21504
    v_mfma_f32_32x32x16_bf16 v[96:111], v[180:183], v[184:187], v[96:111]
    ds_read_b64_tr_b16 v[148:149], v5 offset:20480
    ds_read_b64_tr_b16 v[150:151], v5 offset:21504
    v_mfma_f32_32x32x16_bf16 v[112:127], v[180:183], v[188:191], v[112:127]
    s_waitcnt lgkmcnt(8)
    v_mfma_f32_32x32x16_bf16 v[64:79], v[128:131], v[136:139], v[64:79]
    ds_read_b64_tr_b16 v[160:161], v4 offset:24576
    ds_read_b64_tr_b16 v[162:163], v4 offset:25600
    ds_read_b64_tr_b16 v[168:169], v8 offset:24576
    v_mfma_f32_32x32x16_bf16 v[80:95], v[128:131], v[140:143], v[80:95]
    ds_read_b64_tr_b16 v[170:171], v8 offset:25600
    ds_read_b64_tr_b16 v[172:173], v9 offset:24576
    ds_read_b64_tr_b16 v[174:175], v9 offset:25600
    v_mfma_f32_32x32x16_bf16 v[96:111], v[132:135], v[136:139], v[96:111]
    ds_read_b64_tr_b16 v[164:165], v5 offset:24576
    ds_read_b64_tr_b16 v[166:167], v5 offset:25600
    v_mfma_f32_32x32x16_bf16 v[112:127], v[132:135], v[140:143], v[112:127]
    s_waitcnt lgkmcnt(8)
    v_mfma_f32_32x32x16_bf16 v[64:79], v[144:147], v[152:155], v[64:79]
    ds_read_b64_tr_b16 v[176:177], v4 offset:28672
    ds_read_b64_tr_b16 v[178:179], v4 offset:29696
    ds_read_b64_tr_b16 v[184:185], v8 offset:28672
    v_mfma_f32_32x32x16_bf16 v[80:95], v[144:147], v[156:159], v[80:95]
    ds_read_b64_tr_b16 v[186:187], v8 offset:29696
    ds_read_b64_tr_b16 v[188:189], v9 offset:28672
    ds_read_b64_tr_b16 v[190:191], v9 offset:29696
    v_mfma_f32_32x32x16_bf16 v[96:111], v[148:151], v[152:155], v[96:111]
    ds_read_b64_tr_b16 v[180:181], v5 offset:28672
    ds_read_b64_tr_b16 v[182:183], v5 offset:29696
    v_mfma_f32_32x32x16_bf16 v[112:127], v[148:151], v[156:159], v[112:127]
    s_waitcnt lgkmcnt(8)
    v_mfma_f32_32x32x16_bf16 v[64:79], v[160:163], v[168:171], v[64:79]
    s_waitcnt lgkmcnt(0)
    s_barrier
    ds_read_b64_tr_b16 v[128:129], v4 offset:32768
    ds_read_b64_tr_b16 v[130:131], v4 offset:33792
    ds_read_b64_tr_b16 v[136:137], v8 offset:32768
    v_mfma_f32_32x32x16_bf16 v[80:95], v[160:163], v[172:175], v[80:95]
    ds_read_b64_tr_b16 v[138:139], v8 offset:33792
    ds_read_b64_tr_b16 v[140:141], v9 offset:32768
    ds_read_b64_tr_b16 v[142:143], v9 offset:33792
    v_mfma_f32_32x32x16_bf16 v[96:111], v[164:167], v[168:171], v[96:111]
    ds_read_b64_tr_b16 v[132:133], v5 offset:32768
    ds_read_b64_tr_b16 v[134:135], v5 offset:33792
    v_mfma_f32_32x32x16_bf16 v[112:127], v[164:167], v[172:175], v[112:127]
    s_waitcnt lgkmcnt(8)
    v_mfma_f32_32x32x16_bf16 v[64:79], v[176:179], v[184:187], v[64:79]
    ds_read_b64_tr_b16 v[144:145], v4 offset:36864
    ds_read_b64_tr_b16 v[146:147], v4 offset:37888
    ds_read_b64_tr_b16 v[152:153], v8 offset:36864
    v_mfma_f32_32x32x16_bf16 v[80:95], v[176:179], v[188:191], v[80:95]
    ds_read_b64_tr_b16 v[154:155], v8 offset:37888
    ds_read_b64_tr_b16 v[156:157], v9 offset:36864
    ds_read_b64_tr_b16 v[158:159], v9 offset:37888
    v_mfma_f32_32x32x16_bf16 v[96:111], v[180:183], v[184:187], v[96:111]
    ds_read_b64_tr_b16 v[148:149], v5 offset:36864
    ds_read_b64_tr_b16 v[150:151], v5 offset:37888
    v_mfma_f32_32x32x16_bf16 v[112:127], v[180:183], v[188:191], v[112:127]
    s_waitcnt lgkmcnt(8)
    v_mfma_f32_32x32x16_bf16 v[64:79], v[128:131], v[136:139], v[64:79]
    ds_read_b64_tr_b16 v[160:161], v4 offset:40960
    ds_read_b64_tr_b16 v[162:163], v4 offset:41984
    ds_read_b64_tr_b16 v[168:169], v8 offset:40960
    v_mfma_f32_32x32x16_bf16 v[80:95], v[128:131], v[140:143], v[80:95]
    ds_read_b64_tr_b16 v[170:171], v8 offset:41984
    ds_read_b64_tr_b16 v[172:173], v9 offset:40960
    ds_read_b64_tr_b16 v[174:175], v9 offset:41984
    v_mfma_f32_32x32x16_bf16 v[96:111], v[132:135], v[136:139], v[96:111]
    ds_read_b64_tr_b16 v[164:165], v5 offset:40960
    ds_read_b64_tr_b16 v[166:167], v5 offset:41984
    v_mfma_f32_32x32x16_bf16 v[112:127], v[132:135], v[140:143], v[112:127]
    s_waitcnt lgkmcnt(8)
    v_mfma_f32_32x32x16_bf16 v[64:79], v[144:147], v[152:155], v[64:79]
    ds_read_b64_tr_b16 v[176:177], v4 offset:45056
    ds_read_b64_tr_b16 v[178:179], v4 offset:46080
    ds_read_b64_tr_b16 v[184:185], v8 offset:45056
    v_mfma_f32_32x32x16_bf16 v[80:95], v[144:147], v[156:159], v[80:95]
    ds_read_b64_tr_b16 v[186:187], v8 offset:46080
    ds_read_b64_tr_b16 v[188:189], v9 offset:45056
    ds_read_b64_tr_b16 v[190:191], v9 offset:46080
    v_mfma_f32_32x32x16_bf16 v[96:111], v[148:151], v[152:155], v[96:111]
    ds_read_b64_tr_b16 v[180:181], v5 offset:45056
    ds_read_b64_tr_b16 v[182:183], v5 offset:46080
    v_mfma_f32_32x32x16_bf16 v[112:127], v[148:151], v[156:159], v[112:127]
    s_waitcnt lgkmcnt(8)
    v_mfma_f32_32x32x16_bf16 v[64:79], v[160:163], v[168:171], v[64:79]
    s_waitcnt lgkmcnt(0)
    s_barrier
    ds_read_b64_tr_b16 v[128:129], v4 offset:49152
    ds_read_b64_tr_b16 v[130:131], v4 offset:50176
    ds_read_b64_tr_b16 v[136:137], v8 offset:49152
    v_mfma_f32_32x32x16_bf16 v[80:95], v[160:163], v[172:175], v[80:95]
    ds_read_b64_tr_b16 v[138:139], v8 offset:50176
    ds_read_b64_tr_b16 v[140:141], v9 offset:49152
    ds_read_b64_tr_b16 v[142:143], v9 offset:50176
    v_mfma_f32_32x32x16_bf16 v[96:111], v[164:167], v[168:171], v[96:111]
    ds_read_b64_tr_b16 v[132:133], v5 offset:49152
    ds_read_b64_tr_b16 v[134:135], v5 offset:50176
    v_mfma_f32_32x32x16_bf16 v[112:127], v[164:167], v[172:175], v[112:127]
    s_waitcnt lgkmcnt(8)
    v_mfma_f32_32x32x16_bf16 v[64:79], v[176:179], v[184:187], v[64:79]
    ds_read_b64_tr_b16 v[144:145], v4 offset:53248
    ds_read_b64_tr_b16 v[146:147], v4 offset:54272
    ds_read_b64_tr_b16 v[152:153], v8 offset:53248
    v_mfma_f32_32x32x16_bf16 v[80:95], v[176:179], v[188:191], v[80:95]
    ds_read_b64_tr_b16 v[154:155], v8 offset:54272
    ds_read_b64_tr_b16 v[156:157], v9 offset:53248
    ds_read_b64_tr_b16 v[158:159], v9 offset:54272
    v_mfma_f32_32x32x16_bf16 v[96:111], v[180:183], v[184:187], v[96:111]
    ds_read_b64_tr_b16 v[148:149], v5 offset:53248
    ds_read_b64_tr_b16 v[150:151], v5 offset:54272
    v_mfma_f32_32x32x16_bf16 v[112:127], v[180:183], v[188:191], v[112:127]
    s_waitcnt lgkmcnt(8)
    v_mfma_f32_32x32x16_bf16 v[64:79], v[128:131], v[136:139], v[64:79]
    ds_read_b64_tr_b16 v[160:161], v4 offset:57344
    ds_read_b64_tr_b16 v[162:163], v4 offset:58368
    ds_read_b64_tr_b16 v[168:169], v8 offset:57344
    v_mfma_f32_32x32x16_bf16 v[80:95], v[128:131], v[140:143], v[80:95]
    ds_read_b64_tr_b16 v[170:171], v8 offset:58368
    ds_read_b64_tr_b16 v[172:173], v9 offset:57344
    ds_read_b64_tr_b16 v[174:175], v9 offset:58368
    v_mfma_f32_32x32x16_bf16 v[96:111], v[132:135], v[136:139], v[96:111]
    ds_read_b64_tr_b16 v[164:165], v5 offset:57344
    ds_read_b64_tr_b16 v[166:167], v5 offset:58368
    v_mfma_f32_32x32x16_bf16 v[112:127], v[132:135], v[140:143], v[112:127]
    s_waitcnt lgkmcnt(8)
    v_mfma_f32_32x32x16_bf16 v[64:79], v[144:147], v[152:155], v[64:79]
    ds_read_b64_tr_b16 v[176:177], v4 offset:61440
    ds_read_b64_tr_b16 v[178:179], v4 offset:62464
    ds_read_b64_tr_b16 v[184:185], v8 offset:61440
    v_mfma_f32_32x32x16_bf16 v[80:95], v[144:147], v[156:159], v[80:95]
    ds_read_b64_tr_b16 v[186:187], v8 offset:62464
    ds_read_b64_tr_b16 v[188:189], v9 offset:61440
    ds_read_b64_tr_b16 v[190:191], v9 offset:62464
    v_mfma_f32_32x32x16_bf16 v[96:111], v[148:151], v[152:155], v[96:111]
    ds_read_b64_tr_b16 v[180:181], v5 offset:61440
    ds_read_b64_tr_b16 v[182:183], v5 offset:62464
    v_mfma_f32_32x32x16_bf16 v[112:127], v[148:151], v[156:159], v[112:127]
    s_cmp_eq_u32 s45, 1
    s_cbranch_scc1 L_last_kv
    s_mov_b32 s45, 1
    s_waitcnt lgkmcnt(8)
    v_mfma_f32_32x32x16_bf16 v[64:79], v[160:163], v[168:171], v[64:79]
    s_waitcnt lgkmcnt(0)
    s_barrier
    ds_read_b64_tr_b16 v[128:129], v4 offset:0
    ds_read_b64_tr_b16 v[130:131], v4 offset:1024
    ds_read_b64_tr_b16 v[136:137], v8 offset:0
    v_mfma_f32_32x32x16_bf16 v[80:95], v[160:163], v[172:175], v[80:95]
    ds_read_b64_tr_b16 v[138:139], v8 offset:1024
    ds_read_b64_tr_b16 v[140:141], v9 offset:0
    ds_read_b64_tr_b16 v[142:143], v9 offset:1024
    v_mfma_f32_32x32x16_bf16 v[96:111], v[164:167], v[168:171], v[96:111]
    ds_read_b64_tr_b16 v[132:133], v5 offset:0
    ds_read_b64_tr_b16 v[134:135], v5 offset:1024
    v_mfma_f32_32x32x16_bf16 v[112:127], v[164:167], v[172:175], v[112:127]
    s_waitcnt lgkmcnt(8)
    v_mfma_f32_32x32x16_bf16 v[64:79], v[176:179], v[184:187], v[64:79]
    ds_read_b64_tr_b16 v[144:145], v4 offset:4096
    ds_read_b64_tr_b16 v[146:147], v4 offset:5120
    ds_read_b64_tr_b16 v[152:153], v8 offset:4096
    v_mfma_f32_32x32x16_bf16 v[80:95], v[176:179], v[188:191], v[80:95]
    ds_read_b64_tr_b16 v[154:155], v8 offset:5120
    ds_read_b64_tr_b16 v[156:157], v9 offset:4096
    ds_read_b64_tr_b16 v[158:159], v9 offset:5120
    v_mfma_f32_32x32x16_bf16 v[96:111], v[180:183], v[184:187], v[96:111]
    ds_read_b64_tr_b16 v[148:149], v5 offset:4096
    ds_read_b64_tr_b16 v[150:151], v5 offset:5120
    v_mfma_f32_32x32x16_bf16 v[112:127], v[180:183], v[188:191], v[112:127]
    s_branch L_loop_kv_A1
L_mq_A1:
    s_barrier
    ds_read_b64_tr_b16 v[128:129], v4 offset:0
    ds_read_b64_tr_b16 v[130:131], v4 offset:1024
    ds_read_b64_tr_b16 v[136:137], v8 offset:0
    ds_read_b64_tr_b16 v[138:139], v8 offset:1024
    ds_read_b64_tr_b16 v[140:141], v9 offset:0
    ds_read_b64_tr_b16 v[142:143], v9 offset:1024
    ds_read_b64_tr_b16 v[132:133], v5 offset:0
    ds_read_b64_tr_b16 v[134:135], v5 offset:1024
    ds_read_b64_tr_b16 v[144:145], v4 offset:4096
    ds_read_b64_tr_b16 v[146:147], v4 offset:5120
    ds_read_b64_tr_b16 v[152:153], v8 offset:4096
    ds_read_b64_tr_b16 v[154:155], v8 offset:5120
    ds_read_b64_tr_b16 v[156:157], v9 offset:4096
    ds_read_b64_tr_b16 v[158:159], v9 offset:5120
    ds_read_b64_tr_b16 v[148:149], v5 offset:4096
    ds_read_b64_tr_b16 v[150:151], v5 offset:5120
.p2align 3
L_loop_q_A1:
    s_waitcnt lgkmcnt(8)
    v_mfma_f32_32x32x16_bf16 v[64:79], v[136:139], v[128:131], v[64:79]
    ds_read_b64_tr_b16 v[160:161], v4 offset:8192
    ds_read_b64_tr_b16 v[162:163], v4 offset:9216
    ds_read_b64_tr_b16 v[168:169], v8 offset:8192
    v_mfma_f32_32x32x16_bf16 v[80:95], v[140:143], v[128:131], v[80:95]
    ds_read_b64_tr_b16 v[170:171], v8 offset:9216
    ds_read_b64_tr_b16 v[172:173], v9 offset:8192
    ds_read_b64_tr_b16 v[174:175], v9 offset:9216
    v_mfma_f32_32x32x16_bf16 v[96:111], v[136:139], v[132:135], v[96:111]
    ds_read_b64_tr_b16 v[164:165], v5 offset:8192
    ds_read_b64_tr_b16 v[166:167], v5 offset:9216
    v_mfma_f32_32x32x16_bf16 v[112:127], v[140:143], v[132:135], v[112:127]
    s_waitcnt lgkmcnt(8)
    v_mfma_f32_32x32x16_bf16 v[64:79], v[152:155], v[144:147], v[64:79]
    ds_read_b64_tr_b16 v[176:177], v4 offset:12288
    ds_read_b64_tr_b16 v[178:179], v4 offset:13312
    ds_read_b64_tr_b16 v[184:185], v8 offset:12288
    v_mfma_f32_32x32x16_bf16 v[80:95], v[156:159], v[144:147], v[80:95]
    ds_read_b64_tr_b16 v[186:187], v8 offset:13312
    ds_read_b64_tr_b16 v[188:189], v9 offset:12288
    ds_read_b64_tr_b16 v[190:191], v9 offset:13312
    v_mfma_f32_32x32x16_bf16 v[96:111], v[152:155], v[148:151], v[96:111]
    ds_read_b64_tr_b16 v[180:181], v5 offset:12288
    ds_read_b64_tr_b16 v[182:183], v5 offset:13312
    v_mfma_f32_32x32x16_bf16 v[112:127], v[156:159], v[148:151], v[112:127]
    s_waitcnt lgkmcnt(8)
    v_mfma_f32_32x32x16_bf16 v[64:79], v[168:171], v[160:163], v[64:79]
    s_waitcnt lgkmcnt(0)
    s_barrier
    ds_read_b64_tr_b16 v[128:129], v4 offset:16384
    ds_read_b64_tr_b16 v[130:131], v4 offset:17408
    ds_read_b64_tr_b16 v[136:137], v8 offset:16384
    v_mfma_f32_32x32x16_bf16 v[80:95], v[172:175], v[160:163], v[80:95]
    ds_read_b64_tr_b16 v[138:139], v8 offset:17408
    ds_read_b64_tr_b16 v[140:141], v9 offset:16384
    ds_read_b64_tr_b16 v[142:143], v9 offset:17408
    v_mfma_f32_32x32x16_bf16 v[96:111], v[168:171], v[164:167], v[96:111]
    ds_read_b64_tr_b16 v[132:133], v5 offset:16384
    ds_read_b64_tr_b16 v[134:135], v5 offset:17408
    v_mfma_f32_32x32x16_bf16 v[112:127], v[172:175], v[164:167], v[112:127]
    s_waitcnt lgkmcnt(8)
    v_mfma_f32_32x32x16_bf16 v[64:79], v[184:187], v[176:179], v[64:79]
    ds_read_b64_tr_b16 v[144:145], v4 offset:20480
    ds_read_b64_tr_b16 v[146:147], v4 offset:21504
    ds_read_b64_tr_b16 v[152:153], v8 offset:20480
    v_mfma_f32_32x32x16_bf16 v[80:95], v[188:191], v[176:179], v[80:95]
    ds_read_b64_tr_b16 v[154:155], v8 offset:21504
    ds_read_b64_tr_b16 v[156:157], v9 offset:20480
    ds_read_b64_tr_b16 v[158:159], v9 offset:21504
    v_mfma_f32_32x32x16_bf16 v[96:111], v[184:187], v[180:183], v[96:111]
    ds_read_b64_tr_b16 v[148:149], v5 offset:20480
    ds_read_b64_tr_b16 v[150:151], v5 offset:21504
    v_mfma_f32_32x32x16_bf16 v[112:127], v[188:191], v[180:183], v[112:127]
    s_waitcnt lgkmcnt(8)
    v_mfma_f32_32x32x16_bf16 v[64:79], v[136:139], v[128:131], v[64:79]
    ds_read_b64_tr_b16 v[160:161], v4 offset:24576
    ds_read_b64_tr_b16 v[162:163], v4 offset:25600
    ds_read_b64_tr_b16 v[168:169], v8 offset:24576
    v_mfma_f32_32x32x16_bf16 v[80:95], v[140:143], v[128:131], v[80:95]
    ds_read_b64_tr_b16 v[170:171], v8 offset:25600
    ds_read_b64_tr_b16 v[172:173], v9 offset:24576
    ds_read_b64_tr_b16 v[174:175], v9 offset:25600
    v_mfma_f32_32x32x16_bf16 v[96:111], v[136:139], v[132:135], v[96:111]
    ds_read_b64_tr_b16 v[164:165], v5 offset:24576
    ds_read_b64_tr_b16 v[166:167], v5 offset:25600
    v_mfma_f32_32x32x16_bf16 v[112:127], v[140:143], v[132:135], v[112:127]
    s_waitcnt lgkmcnt(8)
    v_mfma_f32_32x32x16_bf16 v[64:79], v[152:155], v[144:147], v[64:79]
    ds_read_b64_tr_b16 v[176:177], v4 offset:28672
    ds_read_b64_tr_b16 v[178:179], v4 offset:29696
    ds_read_b64_tr_b16 v[184:185], v8 offset:28672
    v_mfma_f32_32x32x16_bf16 v[80:95], v[156:159], v[144:147], v[80:95]
    ds_read_b64_tr_b16 v[186:187], v8 offset:29696
    ds_read_b64_tr_b16 v[188:189], v9 offset:28672
    ds_read_b64_tr_b16 v[190:191], v9 offset:29696
    v_mfma_f32_32x32x16_bf16 v[96:111], v[152:155], v[148:151], v[96:111]
    ds_read_b64_tr_b16 v[180:181], v5 offset:28672
    ds_read_b64_tr_b16 v[182:183], v5 offset:29696
    v_mfma_f32_32x32x16_bf16 v[112:127], v[156:159], v[148:151], v[112:127]
    s_waitcnt lgkmcnt(8)
    v_mfma_f32_32x32x16_bf16 v[64:79], v[168:171], v[160:163], v[64:79]
    s_waitcnt lgkmcnt(0)
    s_barrier
    ds_read_b64_tr_b16 v[128:129], v4 offset:32768
    ds_read_b64_tr_b16 v[130:131], v4 offset:33792
    ds_read_b64_tr_b16 v[136:137], v8 offset:32768
    v_mfma_f32_32x32x16_bf16 v[80:95], v[172:175], v[160:163], v[80:95]
    ds_read_b64_tr_b16 v[138:139], v8 offset:33792
    ds_read_b64_tr_b16 v[140:141], v9 offset:32768
    ds_read_b64_tr_b16 v[142:143], v9 offset:33792
    v_mfma_f32_32x32x16_bf16 v[96:111], v[168:171], v[164:167], v[96:111]
    ds_read_b64_tr_b16 v[132:133], v5 offset:32768
    ds_read_b64_tr_b16 v[134:135], v5 offset:33792
    v_mfma_f32_32x32x16_bf16 v[112:127], v[172:175], v[164:167], v[112:127]
    s_waitcnt lgkmcnt(8)
    v_mfma_f32_32x32x16_bf16 v[64:79], v[184:187], v[176:179], v[64:79]
    ds_read_b64_tr_b16 v[144:145], v4 offset:36864
    ds_read_b64_tr_b16 v[146:147], v4 offset:37888
    ds_read_b64_tr_b16 v[152:153], v8 offset:36864
    v_mfma_f32_32x32x16_bf16 v[80:95], v[188:191], v[176:179], v[80:95]
    ds_read_b64_tr_b16 v[154:155], v8 offset:37888
    ds_read_b64_tr_b16 v[156:157], v9 offset:36864
    ds_read_b64_tr_b16 v[158:159], v9 offset:37888
    v_mfma_f32_32x32x16_bf16 v[96:111], v[184:187], v[180:183], v[96:111]
    ds_read_b64_tr_b16 v[148:149], v5 offset:36864
    ds_read_b64_tr_b16 v[150:151], v5 offset:37888
    v_mfma_f32_32x32x16_bf16 v[112:127], v[188:191], v[180:183], v[112:127]
    s_waitcnt lgkmcnt(8)
    v_mfma_f32_32x32x16_bf16 v[64:79], v[136:139], v[128:131], v[64:79]
    ds_read_b64_tr_b16 v[160:161], v4 offset:40960
    ds_read_b64_tr_b16 v[162:163], v4 offset:41984
    ds_read_b64_tr_b16 v[168:169], v8 offset:40960
    v_mfma_f32_32x32x16_bf16 v[80:95], v[140:143], v[128:131], v[80:95]
    ds_read_b64_tr_b16 v[170:171], v8 offset:41984
    ds_read_b64_tr_b16 v[172:173], v9 offset:40960
    ds_read_b64_tr_b16 v[174:175], v9 offset:41984
    v_mfma_f32_32x32x16_bf16 v[96:111], v[136:139], v[132:135], v[96:111]
    ds_read_b64_tr_b16 v[164:165], v5 offset:40960
    ds_read_b64_tr_b16 v[166:167], v5 offset:41984
    v_mfma_f32_32x32x16_bf16 v[112:127], v[140:143], v[132:135], v[112:127]
    s_waitcnt lgkmcnt(8)
    v_mfma_f32_32x32x16_bf16 v[64:79], v[152:155], v[144:147], v[64:79]
    ds_read_b64_tr_b16 v[176:177], v4 offset:45056
    ds_read_b64_tr_b16 v[178:179], v4 offset:46080
    ds_read_b64_tr_b16 v[184:185], v8 offset:45056
    v_mfma_f32_32x32x16_bf16 v[80:95], v[156:159], v[144:147], v[80:95]
    ds_read_b64_tr_b16 v[186:187], v8 offset:46080
    ds_read_b64_tr_b16 v[188:189], v9 offset:45056
    ds_read_b64_tr_b16 v[190:191], v9 offset:46080
    v_mfma_f32_32x32x16_bf16 v[96:111], v[152:155], v[148:151], v[96:111]
    ds_read_b64_tr_b16 v[180:181], v5 offset:45056
    ds_read_b64_tr_b16 v[182:183], v5 offset:46080
    v_mfma_f32_32x32x16_bf16 v[112:127], v[156:159], v[148:151], v[112:127]
    s_waitcnt lgkmcnt(8)
    v_mfma_f32_32x32x16_bf16 v[64:79], v[168:171], v[160:163], v[64:79]
    s_waitcnt lgkmcnt(0)
    s_barrier
    ds_read_b64_tr_b16 v[128:129], v4 offset:49152
    ds_read_b64_tr_b16 v[130:131], v4 offset:50176
    ds_read_b64_tr_b16 v[136:137], v8 offset:49152
    v_mfma_f32_32x32x16_bf16 v[80:95], v[172:175], v[160:163], v[80:95]
    ds_read_b64_tr_b16 v[138:139], v8 offset:50176
    ds_read_b64_tr_b16 v[140:141], v9 offset:49152
    ds_read_b64_tr_b16 v[142:143], v9 offset:50176
    v_mfma_f32_32x32x16_bf16 v[96:111], v[168:171], v[164:167], v[96:111]
    ds_read_b64_tr_b16 v[132:133], v5 offset:49152
    ds_read_b64_tr_b16 v[134:135], v5 offset:50176
    v_mfma_f32_32x32x16_bf16 v[112:127], v[172:175], v[164:167], v[112:127]
    s_waitcnt lgkmcnt(8)
    v_mfma_f32_32x32x16_bf16 v[64:79], v[184:187], v[176:179], v[64:79]
    ds_read_b64_tr_b16 v[144:145], v4 offset:53248
    ds_read_b64_tr_b16 v[146:147], v4 offset:54272
    ds_read_b64_tr_b16 v[152:153], v8 offset:53248
    v_mfma_f32_32x32x16_bf16 v[80:95], v[188:191], v[176:179], v[80:95]
    ds_read_b64_tr_b16 v[154:155], v8 offset:54272
    ds_read_b64_tr_b16 v[156:157], v9 offset:53248
    ds_read_b64_tr_b16 v[158:159], v9 offset:54272
    v_mfma_f32_32x32x16_bf16 v[96:111], v[184:187], v[180:183], v[96:111]
    ds_read_b64_tr_b16 v[148:149], v5 offset:53248
    ds_read_b64_tr_b16 v[150:151], v5 offset:54272
    v_mfma_f32_32x32x16_bf16 v[112:127], v[188:191], v[180:183], v[112:127]
    s_waitcnt lgkmcnt(8)
    v_mfma_f32_32x32x16_bf16 v[64:79], v[136:139], v[128:131], v[64:79]
    ds_read_b64_tr_b16 v[160:161], v4 offset:57344
    ds_read_b64_tr_b16 v[162:163], v4 offset:58368
    ds_read_b64_tr_b16 v[168:169], v8 offset:57344
    v_mfma_f32_32x32x16_bf16 v[80:95], v[140:143], v[128:131], v[80:95]
    ds_read_b64_tr_b16 v[170:171], v8 offset:58368
    ds_read_b64_tr_b16 v[172:173], v9 offset:57344
    ds_read_b64_tr_b16 v[174:175], v9 offset:58368
    v_mfma_f32_32x32x16_bf16 v[96:111], v[136:139], v[132:135], v[96:111]
    ds_read_b64_tr_b16 v[164:165], v5 offset:57344
    ds_read_b64_tr_b16 v[166:167], v5 offset:58368
    v_mfma_f32_32x32x16_bf16 v[112:127], v[140:143], v[132:135], v[112:127]
    s_waitcnt lgkmcnt(8)
    v_mfma_f32_32x32x16_bf16 v[64:79], v[152:155], v[144:147], v[64:79]
    ds_read_b64_tr_b16 v[176:177], v4 offset:61440
    ds_read_b64_tr_b16 v[178:179], v4 offset:62464
    ds_read_b64_tr_b16 v[184:185], v8 offset:61440
    v_mfma_f32_32x32x16_bf16 v[80:95], v[156:159], v[144:147], v[80:95]
    ds_read_b64_tr_b16 v[186:187], v8 offset:62464
    ds_read_b64_tr_b16 v[188:189], v9 offset:61440
    ds_read_b64_tr_b16 v[190:191], v9 offset:62464
    v_mfma_f32_32x32x16_bf16 v[96:111], v[152:155], v[148:151], v[96:111]
    ds_read_b64_tr_b16 v[180:181], v5 offset:61440
    ds_read_b64_tr_b16 v[182:183], v5 offset:62464
    v_mfma_f32_32x32x16_bf16 v[112:127], v[156:159], v[148:151], v[112:127]
    s_cmp_eq_u32 s45, 1
    s_cbranch_scc1 L_last_q
    s_mov_b32 s45, 1
    s_waitcnt lgkmcnt(8)
    v_mfma_f32_32x32x16_bf16 v[64:79], v[168:171], v[160:163], v[64:79]
    s_waitcnt lgkmcnt(0)
    s_barrier
    ds_read_b64_tr_b16 v[128:129], v4 offset:0
    ds_read_b64_tr_b16 v[130:131], v4 offset:1024
    ds_read_b64_tr_b16 v[136:137], v8 offset:0
    v_mfma_f32_32x32x16_bf16 v[80:95], v[172:175], v[160:163], v[80:95]
    ds_read_b64_tr_b16 v[138:139], v8 offset:1024
    ds_read_b64_tr_b16 v[140:141], v9 offset:0
    ds_read_b64_tr_b16 v[142:143], v9 offset:1024
    v_mfma_f32_32x32x16_bf16 v[96:111], v[168:171], v[164:167], v[96:111]
    ds_read_b64_tr_b16 v[132:133], v5 offset:0
    ds_read_b64_tr_b16 v[134:135], v5 offset:1024
    v_mfma_f32_32x32x16_bf16 v[112:127], v[172:175], v[164:167], v[112:127]
    s_waitcnt lgkmcnt(8)
    v_mfma_f32_32x32x16_bf16 v[64:79], v[184:187], v[176:179], v[64:79]
    ds_read_b64_tr_b16 v[144:145], v4 offset:4096
    ds_read_b64_tr_b16 v[146:147], v4 offset:5120
    ds_read_b64_tr_b16 v[152:153], v8 offset:4096
    v_mfma_f32_32x32x16_bf16 v[80:95], v[188:191], v[176:179], v[80:95]
    ds_read_b64_tr_b16 v[154:155], v8 offset:5120
    ds_read_b64_tr_b16 v[156:157], v9 offset:4096
    ds_read_b64_tr_b16 v[158:159], v9 offset:5120
    v_mfma_f32_32x32x16_bf16 v[96:111], v[184:187], v[180:183], v[96:111]
    ds_read_b64_tr_b16 v[148:149], v5 offset:4096
    ds_read_b64_tr_b16 v[150:151], v5 offset:5120
    v_mfma_f32_32x32x16_bf16 v[112:127], v[188:191], v[180:183], v[112:127]
    s_branch L_loop_q_A1
L_last_kv:
    s_waitcnt vmcnt(0) lgkmcnt(0)
    v_mfma_f32_32x32x16_bf16 v[64:79], v[160:163], v[168:171], v[64:79]
    s_barrier
    ds_read_b32 v16, v11
    ds_read_b32 v18, v11 offset:256
    ds_read_b128 v[192:195], v10 offset:0
    v_mfma_f32_32x32x16_bf16 v[80:95], v[160:163], v[172:175], v[80:95]
    ds_read_b128 v[208:211], v10 offset:512
    ds_read_b128 v[224:227], v10 offset:1024
    ds_read_b128 v[196:199], v10 offset:32
    v_mfma_f32_32x32x16_bf16 v[96:111], v[164:167], v[168:171], v[96:111]
    ds_read_b128 v[212:215], v10 offset:544
    ds_read_b128 v[228:231], v10 offset:1056
    ds_read_b128 v[200:203], v10 offset:64
    v_mfma_f32_32x32x16_bf16 v[112:127], v[164:167], v[172:175], v[112:127]
    ds_read_b128 v[216:219], v10 offset:576
    ds_read_b128 v[232:235], v10 offset:1088
    ds_read_b128 v[204:207], v10 offset:96
    v_mfma_f32_32x32x16_bf16 v[64:79], v[176:179], v[184:187], v[64:79]
    ds_read_b128 v[220:223], v10 offset:608
    ds_read_b128 v[236:239], v10 offset:1120
    v_mfma_f32_32x32x16_bf16 v[80:95], v[176:179], v[188:191], v[80:95]
    v_mfma_f32_32x32x16_bf16 v[96:111], v[180:183], v[184:187], v[96:111]
    v_mfma_f32_32x32x16_bf16 v[112:127], v[180:183], v[188:191], v[112:127]
    ds_read_b128 v[128:131], v10 offset:128
    ds_read_b128 v[144:147], v10 offset:640
    ds_read_b128 v[160:163], v10 offset:1152
    ds_read_b128 v[132:135], v10 offset:160
    ds_read_b128 v[148:151], v10 offset:672
    ds_read_b128 v[164:167], v10 offset:1184
    ds_read_b128 v[136:139], v10 offset:192
    ds_read_b128 v[152:155], v10 offset:704
    ds_read_b128 v[168:171], v10 offset:1216
    ds_read_b128 v[140:143], v10 offset:224
    ds_read_b128 v[156:159], v10 offset:736
    ds_read_b128 v[172:175], v10 offset:1248
    v_mov_b32 v20, 0
    s_lshl_b32 s43, s28, 11
    s_add_u32 s43, s43, 133120
    v_bfe_u32 v12, v1, 4, 1
    v_lshlrev_b32 v12, 10, v12
    v_lshl_add_u32 v12, v3, 8, v12
    v_and_b32 v13, 15, v1
    v_lshl_add_u32 v12, v13, 4, v12
    v_add_u32 v12, s43, v12
    s_lshl_b32 s43, s28, 8
    s_add_u32 s43, s43, 141312
    v_lshl_add_u32 v13, v1, 2, s43
    s_mov_b32 s50, 0x0000ffff
    s_mov_b32 s51, 0x0000ffff
    s_waitcnt lgkmcnt(12)
    v_pk_fma_f32 v[240:241], v[192:193], v[16:17], v[64:65] op_sel_hi:[1,0,1]
    v_pk_mul_f32 v[242:243], v[240:241], v[224:225] op_sel_hi:[1,1]
    v_pk_fma_f32 v[244:245], v[240:241], v[208:209], 1.0 op_sel_hi:[1,1,0]
    v_exp_f32_e64 v242, v242 clamp
    v_exp_f32_e64 v243, v243 clamp
    v_max_f32 v244, v244, v242
    v_max_f32 v245, v245, v243
    v_pk_add_f32 v[244:245], v[244:245], s[46:47]
    v_cvt_pk_bf16_f32 v32, v244, v245
    v_pk_fma_f32 v[252:253], v[192:193], v[18:19], v[80:81] op_sel_hi:[1,0,1]
    v_pk_mul_f32 v[252:253], v[252:253], v[208:209]
    v_cvt_pk_bf16_f32 v48, v252, v253
    v_dot2c_f32_bf16 v20, s48, v32
    v_pk_fma_f32 v[246:247], v[194:195], v[16:17], v[66:67] op_sel_hi:[1,0,1]
    v_pk_mul_f32 v[248:249], v[246:247], v[226:227] op_sel_hi:[1,1]
    v_pk_fma_f32 v[250:251], v[246:247], v[210:211], 1.0 op_sel_hi:[1,1,0]
    v_exp_f32_e64 v248, v248 clamp
    v_exp_f32_e64 v249, v249 clamp
    v_max_f32 v250, v250, v248
    v_max_f32 v251, v251, v249
    v_pk_add_f32 v[250:251], v[250:251], s[46:47]
    v_cvt_pk_bf16_f32 v33, v250, v251
    v_pk_fma_f32 v[254:255], v[194:195], v[18:19], v[82:83] op_sel_hi:[1,0,1]
    v_pk_mul_f32 v[254:255], v[254:255], v[210:211]
    v_cvt_pk_bf16_f32 v49, v254, v255
    v_dot2c_f32_bf16 v20, s48, v33
    v_pk_fma_f32 v[240:241], v[196:197], v[16:17], v[68:69] op_sel_hi:[1,0,1]
    v_pk_mul_f32 v[242:243], v[240:241], v[228:229] op_sel_hi:[1,1]
    v_pk_fma_f32 v[244:245], v[240:241], v[212:213], 1.0 op_sel_hi:[1,1,0]
    v_exp_f32_e64 v242, v242 clamp
    v_exp_f32_e64 v243, v243 clamp
    v_max_f32 v244, v244, v242
    v_max_f32 v245, v245, v243
    v_pk_add_f32 v[244:245], v[244:245], s[46:47]
    v_cvt_pk_bf16_f32 v34, v244, v245
    v_pk_fma_f32 v[252:253], v[196:197], v[18:19], v[84:85] op_sel_hi:[1,0,1]
    v_pk_mul_f32 v[252:253], v[252:253], v[212:213]
    v_cvt_pk_bf16_f32 v50, v252, v253
    v_dot2c_f32_bf16 v20, s48, v34
    v_pk_fma_f32 v[246:247], v[198:199], v[16:17], v[70:71] op_sel_hi:[1,0,1]
    v_pk_mul_f32 v[248:249], v[246:247], v[230:231] op_sel_hi:[1,1]
    v_pk_fma_f32 v[250:251], v[246:247], v[214:215], 1.0 op_sel_hi:[1,1,0]
    v_exp_f32_e64 v248, v248 clamp
    v_exp_f32_e64 v249, v249 clamp
    v_max_f32 v250, v250, v248
    v_max_f32 v251, v251, v249
    v_pk_add_f32 v[250:251], v[250:251], s[46:47]
    v_cvt_pk_bf16_f32 v35, v250, v251
    v_pk_fma_f32 v[254:255], v[198:199], v[18:19], v[86:87] op_sel_hi:[1,0,1]
    v_pk_mul_f32 v[254:255], v[254:255], v[214:215]
    v_cvt_pk_bf16_f32 v51, v254, v255
    v_dot2c_f32_bf16 v20, s48, v35
    v_pk_fma_f32 v[240:241], v[200:201], v[16:17], v[72:73] op_sel_hi:[1,0,1]
    v_pk_mul_f32 v[242:243], v[240:241], v[232:233] op_sel_hi:[1,1]
    v_pk_fma_f32 v[244:245], v[240:241], v[216:217], 1.0 op_sel_hi:[1,1,0]
    v_exp_f32_e64 v242, v242 clamp
    v_exp_f32_e64 v243, v243 clamp
    v_max_f32 v244, v244, v242
    v_max_f32 v245, v245, v243
    v_pk_add_f32 v[244:245], v[244:245], s[46:47]
    v_cvt_pk_bf16_f32 v36, v244, v245
    v_pk_fma_f32 v[252:253], v[200:201], v[18:19], v[88:89] op_sel_hi:[1,0,1]
    v_pk_mul_f32 v[252:253], v[252:253], v[216:217]
    v_cvt_pk_bf16_f32 v52, v252, v253
    v_dot2c_f32_bf16 v20, s48, v36
    v_pk_fma_f32 v[246:247], v[202:203], v[16:17], v[74:75] op_sel_hi:[1,0,1]
    v_pk_mul_f32 v[248:249], v[246:247], v[234:235] op_sel_hi:[1,1]
    v_pk_fma_f32 v[250:251], v[246:247], v[218:219], 1.0 op_sel_hi:[1,1,0]
    v_exp_f32_e64 v248, v248 clamp
    v_exp_f32_e64 v249, v249 clamp
    v_max_f32 v250, v250, v248
    v_max_f32 v251, v251, v249
    v_pk_add_f32 v[250:251], v[250:251], s[46:47]
    v_cvt_pk_bf16_f32 v37, v250, v251
    v_pk_fma_f32 v[254:255], v[202:203], v[18:19], v[90:91] op_sel_hi:[1,0,1]
    v_pk_mul_f32 v[254:255], v[254:255], v[218:219]
    v_cvt_pk_bf16_f32 v53, v254, v255
    v_dot2c_f32_bf16 v20, s48, v37
    v_pk_fma_f32 v[240:241], v[204:205], v[16:17], v[76:77] op_sel_hi:[1,0,1]
    v_pk_mul_f32 v[242:243], v[240:241], v[236:237] op_sel_hi:[1,1]
    v_pk_fma_f32 v[244:245], v[240:241], v[220:221], 1.0 op_sel_hi:[1,1,0]
    v_exp_f32_e64 v242, v242 clamp
    v_exp_f32_e64 v243, v243 clamp
    v_max_f32 v244, v244, v242
    v_max_f32 v245, v245, v243
    v_pk_add_f32 v[244:245], v[244:245], s[46:47]
    v_cvt_pk_bf16_f32 v38, v244, v245
    v_pk_fma_f32 v[252:253], v[204:205], v[18:19], v[92:93] op_sel_hi:[1,0,1]
    v_pk_mul_f32 v[252:253], v[252:253], v[220:221]
    v_cvt_pk_bf16_f32 v54, v252, v253
    v_dot2c_f32_bf16 v20, s48, v38
    v_pk_fma_f32 v[246:247], v[206:207], v[16:17], v[78:79] op_sel_hi:[1,0,1]
    v_pk_mul_f32 v[248:249], v[246:247], v[238:239] op_sel_hi:[1,1]
    v_pk_fma_f32 v[250:251], v[246:247], v[222:223], 1.0 op_sel_hi:[1,1,0]
    v_exp_f32_e64 v248, v248 clamp
    v_exp_f32_e64 v249, v249 clamp
    v_max_f32 v250, v250, v248
    v_max_f32 v251, v251, v249
    v_pk_add_f32 v[250:251], v[250:251], s[46:47]
    v_cvt_pk_bf16_f32 v39, v250, v251
    v_pk_fma_f32 v[254:255], v[206:207], v[18:19], v[94:95] op_sel_hi:[1,0,1]
    v_pk_mul_f32 v[254:255], v[254:255], v[222:223]
    v_cvt_pk_bf16_f32 v55, v254, v255
    v_dot2c_f32_bf16 v20, s48, v39
    s_waitcnt lgkmcnt(0)
    v_pk_fma_f32 v[240:241], v[128:129], v[16:17], v[96:97] op_sel_hi:[1,0,1]
    v_pk_mul_f32 v[242:243], v[240:241], v[160:161] op_sel_hi:[1,1]
    v_pk_fma_f32 v[244:245], v[240:241], v[144:145], 1.0 op_sel_hi:[1,1,0]
    v_exp_f32_e64 v242, v242 clamp
    v_exp_f32_e64 v243, v243 clamp
    v_max_f32 v244, v244, v242
    v_max_f32 v245, v245, v243
    v_pk_add_f32 v[244:245], v[244:245], s[46:47]
    v_cvt_pk_bf16_f32 v40, v244, v245
    v_pk_fma_f32 v[252:253], v[128:129], v[18:19], v[112:113] op_sel_hi:[1,0,1]
    v_pk_mul_f32 v[252:253], v[252:253], v[144:145]
    v_cvt_pk_bf16_f32 v56, v252, v253
    v_dot2c_f32_bf16 v20, s48, v40
    v_pk_fma_f32 v[246:247], v[130:131], v[16:17], v[98:99] op_sel_hi:[1,0,1]
    v_pk_mul_f32 v[248:249], v[246:247], v[162:163] op_sel_hi:[1,1]
    v_pk_fma_f32 v[250:251], v[246:247], v[146:147], 1.0 op_sel_hi:[1,1,0]
    v_exp_f32_e64 v248, v248 clamp
    v_exp_f32_e64 v249, v249 clamp
    v_max_f32 v250, v250, v248
    v_max_f32 v251, v251, v249
    v_pk_add_f32 v[250:251], v[250:251], s[46:47]
    v_cvt_pk_bf16_f32 v41, v250, v251
    v_pk_fma_f32 v[254:255], v[130:131], v[18:19], v[114:115] op_sel_hi:[1,0,1]
    v_pk_mul_f32 v[254:255], v[254:255], v[146:147]
    v_cvt_pk_bf16_f32 v57, v254, v255
    v_dot2c_f32_bf16 v20, s48, v41
    v_pk_fma_f32 v[240:241], v[132:133], v[16:17], v[100:101] op_sel_hi:[1,0,1]
    v_pk_mul_f32 v[242:243], v[240:241], v[164:165] op_sel_hi:[1,1]
    v_pk_fma_f32 v[244:245], v[240:241], v[148:149], 1.0 op_sel_hi:[1,1,0]
    v_exp_f32_e64 v242, v242 clamp
    v_exp_f32_e64 v243, v243 clamp
    v_max_f32 v244, v244, v242
    v_max_f32 v245, v245, v243
    v_pk_add_f32 v[244:245], v[244:245], s[46:47]
    v_cvt_pk_bf16_f32 v42, v244, v245
    v_pk_fma_f32 v[252:253], v[132:133], v[18:19], v[116:117] op_sel_hi:[1,0,1]
    v_pk_mul_f32 v[252:253], v[252:253], v[148:149]
    v_cvt_pk_bf16_f32 v58, v252, v253
    v_dot2c_f32_bf16 v20, s48, v42
    v_pk_fma_f32 v[246:247], v[134:135], v[16:17], v[102:103] op_sel_hi:[1,0,1]
    v_pk_mul_f32 v[248:249], v[246:247], v[166:167] op_sel_hi:[1,1]
    v_pk_fma_f32 v[250:251], v[246:247], v[150:151], 1.0 op_sel_hi:[1,1,0]
    v_exp_f32_e64 v248, v248 clamp
    v_exp_f32_e64 v249, v249 clamp
    v_max_f32 v250, v250, v248
    v_max_f32 v251, v251, v249
    v_pk_add_f32 v[250:251], v[250:251], s[46:47]
    v_cvt_pk_bf16_f32 v43, v250, v251
    v_pk_fma_f32 v[254:255], v[134:135], v[18:19], v[118:119] op_sel_hi:[1,0,1]
    v_pk_mul_f32 v[254:255], v[254:255], v[150:151]
    v_cvt_pk_bf16_f32 v59, v254, v255
    v_dot2c_f32_bf16 v20, s48, v43
    v_pk_fma_f32 v[240:241], v[136:137], v[16:17], v[104:105] op_sel_hi:[1,0,1]
    v_pk_mul_f32 v[242:243], v[240:241], v[168:169] op_sel_hi:[1,1]
    v_pk_fma_f32 v[244:245], v[240:241], v[152:153], 1.0 op_sel_hi:[1,1,0]
    v_exp_f32_e64 v242, v242 clamp
    v_exp_f32_e64 v243, v243 clamp
    v_max_f32 v244, v244, v242
    v_max_f32 v245, v245, v243
    v_pk_add_f32 v[244:245], v[244:245], s[46:47]
    v_cvt_pk_bf16_f32 v44, v244, v245
    v_pk_fma_f32 v[252:253], v[136:137], v[18:19], v[120:121] op_sel_hi:[1,0,1]
    v_pk_mul_f32 v[252:253], v[252:253], v[152:153]
    v_cvt_pk_bf16_f32 v60, v252, v253
    v_dot2c_f32_bf16 v20, s48, v44
    v_pk_fma_f32 v[246:247], v[138:139], v[16:17], v[106:107] op_sel_hi:[1,0,1]
    v_pk_mul_f32 v[248:249], v[246:247], v[170:171] op_sel_hi:[1,1]
    v_pk_fma_f32 v[250:251], v[246:247], v[154:155], 1.0 op_sel_hi:[1,1,0]
    v_exp_f32_e64 v248, v248 clamp
    v_exp_f32_e64 v249, v249 clamp
    v_max_f32 v250, v250, v248
    v_max_f32 v251, v251, v249
    v_pk_add_f32 v[250:251], v[250:251], s[46:47]
    v_cvt_pk_bf16_f32 v45, v250, v251
    v_pk_fma_f32 v[254:255], v[138:139], v[18:19], v[122:123] op_sel_hi:[1,0,1]
    v_pk_mul_f32 v[254:255], v[254:255], v[154:155]
    v_cvt_pk_bf16_f32 v61, v254, v255
    v_dot2c_f32_bf16 v20, s48, v45
    v_pk_fma_f32 v[240:241], v[140:141], v[16:17], v[108:109] op_sel_hi:[1,0,1]
    v_pk_mul_f32 v[242:243], v[240:241], v[172:173] op_sel_hi:[1,1]
    v_pk_fma_f32 v[244:245], v[240:241], v[156:157], 1.0 op_sel_hi:[1,1,0]
    v_exp_f32_e64 v242, v242 clamp
    v_exp_f32_e64 v243, v243 clamp
    v_max_f32 v244, v244, v242
    v_max_f32 v245, v245, v243
    v_pk_add_f32 v[244:245], v[244:245], s[46:47]
    v_cvt_pk_bf16_f32 v46, v244, v245
    v_pk_fma_f32 v[252:253], v[140:141], v[18:19], v[124:125] op_sel_hi:[1,0,1]
    v_pk_mul_f32 v[252:253], v[252:253], v[156:157]
    v_cvt_pk_bf16_f32 v62, v252, v253
    v_dot2c_f32_bf16 v20, s48, v46
    v_pk_fma_f32 v[246:247], v[142:143], v[16:17], v[110:111] op_sel_hi:[1,0,1]
    v_pk_mul_f32 v[248:249], v[246:247], v[174:175] op_sel_hi:[1,1]
    v_pk_fma_f32 v[250:251], v[246:247], v[158:159], 1.0 op_sel_hi:[1,1,0]
    v_exp_f32_e64 v248, v248 clamp
    v_exp_f32_e64 v249, v249 clamp
    v_max_f32 v250, v250, v248
    v_max_f32 v251, v251, v249
    v_pk_add_f32 v[250:251], v[250:251], s[46:47]
    v_cvt_pk_bf16_f32 v47, v250, v251
    v_pk_fma_f32 v[254:255], v[142:143], v[18:19], v[126:127] op_sel_hi:[1,0,1]
    v_pk_mul_f32 v[254:255], v[254:255], v[158:159]
    v_cvt_pk_bf16_f32 v63, v254, v255
    v_dot2c_f32_bf16 v20, s48, v47
    v_mfma_f32_32x32x16_bf16 v[64:79], v[32:35], v[48:51], 0
    v_mfma_f32_32x32x16_bf16 v[64:79], v[36:39], v[52:55], v[64:79]
    v_mfma_f32_32x32x16_bf16 v[64:79], v[40:43], v[56:59], v[64:79]
    v_mfma_f32_32x32x16_bf16 v[64:79], v[44:47], v[60:63], v[64:79]
    ds_write_b32 v13, v20
    s_mov_b64 exec, s[50:51]
    s_nop 9
    ds_write_b128 v12, v[64:67]
    ds_write_b128 v12, v[68:71] offset:512
    s_not_b64 exec, exec
    ds_write_b128 v12, v[72:75]
    ds_write_b128 v12, v[76:79] offset:512
    s_mov_b64 exec, -1
    s_waitcnt lgkmcnt(0)
    s_barrier
    s_branch L_A_end
L_last_q:
    s_waitcnt vmcnt(0) lgkmcnt(0)
    v_mfma_f32_32x32x16_bf16 v[64:79], v[168:171], v[160:163], v[64:79]
    s_barrier
    ds_read_b32 v16, v10 offset:0
    ds_read_b32 v18, v10 offset:512
    ds_read_b32 v20, v10 offset:1024
    v_mfma_f32_32x32x16_bf16 v[80:95], v[172:175], v[160:163], v[80:95]
    ds_read_b32 v22, v10 offset:128
    ds_read_b32 v24, v10 offset:640
    ds_read_b32 v26, v10 offset:1152
    v_mfma_f32_32x32x16_bf16 v[96:111], v[168:171], v[164:167], v[96:111]
    ds_read_b128 v[192:195], v11 offset:0
    ds_read_b128 v[196:199], v11 offset:32
    ds_read_b128 v[200:203], v11 offset:64
    v_mfma_f32_32x32x16_bf16 v[112:127], v[172:175], v[164:167], v[112:127]
    ds_read_b128 v[204:207], v11 offset:96
    ds_read_b128 v[208:211], v11 offset:256
    ds_read_b128 v[212:215], v11 offset:288
    v_mfma_f32_32x32x16_bf16 v[64:79], v[184:187], v[176:179], v[64:79]
    ds_read_b128 v[216:219], v11 offset:320
    ds_read_b128 v[220:223], v11 offset:352
    v_mfma_f32_32x32x16_bf16 v[80:95], v[188:191], v[176:179], v[80:95]
    v_mfma_f32_32x32x16_bf16 v[96:111], v[184:187], v[180:183], v[96:111]
    v_mfma_f32_32x32x16_bf16 v[112:127], v[188:191], v[180:183], v[112:127]
    v_lshlrev_b32 v12, 4, v1
    s_lshl_b32 s43, s29, 17
    s_lshl_b32 s49, s41, 16
    s_add_u32 s43, s43, s49
    s_lshl_b32 s49, s35, 13
    s_add_u32 s43, s43, s49
    s_lshl_b32 s49, s42, 11
    s_add_u32 s43, s43, s49
    s_add_u32 s43, s43, s68
    s_waitcnt lgkmcnt(0)
    s_add_u32 s49, s43, 0
    v_pk_fma_f32 v[240:241], v[16:17], v[192:193], v[64:65] op_sel_hi:[0,1,1]
    v_pk_mul_f32 v[242:243], v[240:241], v[20:21] op_sel_hi:[1,0]
    v_pk_fma_f32 v[244:245], v[240:241], v[18:19], 1.0 op_sel_hi:[1,0,0]
    v_exp_f32_e64 v242, v242 clamp
    v_exp_f32_e64 v243, v243 clamp
    v_max_f32 v244, v244, v242
    v_max_f32 v245, v245, v243
    v_pk_add_f32 v[244:245], v[244:245], s[46:47]
    v_cvt_pk_bf16_f32 v32, v244, v245
    v_pk_fma_f32 v[246:247], v[16:17], v[194:195], v[66:67] op_sel_hi:[0,1,1]
    v_pk_mul_f32 v[248:249], v[246:247], v[20:21] op_sel_hi:[1,0]
    v_pk_fma_f32 v[250:251], v[246:247], v[18:19], 1.0 op_sel_hi:[1,0,0]
    v_exp_f32_e64 v248, v248 clamp
    v_exp_f32_e64 v249, v249 clamp
    v_max_f32 v250, v250, v248
    v_max_f32 v251, v251, v249
    v_pk_add_f32 v[250:251], v[250:251], s[46:47]
    v_cvt_pk_bf16_f32 v33, v250, v251
    v_pk_fma_f32 v[240:241], v[16:17], v[196:197], v[68:69] op_sel_hi:[0,1,1]
    v_pk_mul_f32 v[242:243], v[240:241], v[20:21] op_sel_hi:[1,0]
    v_pk_fma_f32 v[244:245], v[240:241], v[18:19], 1.0 op_sel_hi:[1,0,0]
    v_exp_f32_e64 v242, v242 clamp
    v_exp_f32_e64 v243, v243 clamp
    v_max_f32 v244, v244, v242
    v_max_f32 v245, v245, v243
    v_pk_add_f32 v[244:245], v[244:245], s[46:47]
    v_cvt_pk_bf16_f32 v34, v244, v245
    v_pk_fma_f32 v[246:247], v[16:17], v[198:199], v[70:71] op_sel_hi:[0,1,1]
    v_pk_mul_f32 v[248:249], v[246:247], v[20:21] op_sel_hi:[1,0]
    v_pk_fma_f32 v[250:251], v[246:247], v[18:19], 1.0 op_sel_hi:[1,0,0]
    v_exp_f32_e64 v248, v248 clamp
    v_exp_f32_e64 v249, v249 clamp
    v_max_f32 v250, v250, v248
    v_max_f32 v251, v251, v249
    v_pk_add_f32 v[250:251], v[250:251], s[46:47]
    v_cvt_pk_bf16_f32 v35, v250, v251
    buffer_store_dwordx4 v[32:35], v12, s[20:23], s49 offen offset:0 sc1
    v_pk_fma_f32 v[240:241], v[16:17], v[200:201], v[72:73] op_sel_hi:[0,1,1]
    v_pk_mul_f32 v[242:243], v[240:241], v[20:21] op_sel_hi:[1,0]
    v_pk_fma_f32 v[244:245], v[240:241], v[18:19], 1.0 op_sel_hi:[1,0,0]
    v_exp_f32_e64 v242, v242 clamp
    v_exp_f32_e64 v243, v243 clamp
    v_max_f32 v244, v244, v242
    v_max_f32 v245, v245, v243
    v_pk_add_f32 v[244:245], v[244:245], s[46:47]
    v_cvt_pk_bf16_f32 v36, v244, v245
    v_pk_fma_f32 v[246:247], v[16:17], v[202:203], v[74:75] op_sel_hi:[0,1,1]
    v_pk_mul_f32 v[248:249], v[246:247], v[20:21] op_sel_hi:[1,0]
    v_pk_fma_f32 v[250:251], v[246:247], v[18:19], 1.0 op_sel_hi:[1,0,0]
    v_exp_f32_e64 v248, v248 clamp
    v_exp_f32_e64 v249, v249 clamp
    v_max_f32 v250, v250, v248
    v_max_f32 v251, v251, v249
    v_pk_add_f32 v[250:251], v[250:251], s[46:47]
    v_cvt_pk_bf16_f32 v37, v250, v251
    v_pk_fma_f32 v[240:241], v[16:17], v[204:205], v[76:77] op_sel_hi:[0,1,1]
    v_pk_mul_f32 v[242:243], v[240:241], v[20:21] op_sel_hi:[1,0]
    v_pk_fma_f32 v[244:245], v[240:241], v[18:19], 1.0 op_sel_hi:[1,0,0]
    v_exp_f32_e64 v242, v242 clamp
    v_exp_f32_e64 v243, v243 clamp
    v_max_f32 v244, v244, v242
    v_max_f32 v245, v245, v243
    v_pk_add_f32 v[244:245], v[244:245], s[46:47]
    v_cvt_pk_bf16_f32 v38, v244, v245
    v_pk_fma_f32 v[246:247], v[16:17], v[206:207], v[78:79] op_sel_hi:[0,1,1]
    v_pk_mul_f32 v[248:249], v[246:247], v[20:21] op_sel_hi:[1,0]
    v_pk_fma_f32 v[250:251], v[246:247], v[18:19], 1.0 op_sel_hi:[1,0,0]
    v_exp_f32_e64 v248, v248 clamp
    v_exp_f32_e64 v249, v249 clamp
    v_max_f32 v250, v250, v248
    v_max_f32 v251, v251, v249
    v_pk_add_f32 v[250:251], v[250:251], s[46:47]
    v_cvt_pk_bf16_f32 v39, v250, v251
    buffer_store_dwordx4 v[36:39], v12, s[20:23], s49 offen offset:1024 sc1
    s_add_u32 s49, s43, 4096
    v_pk_fma_f32 v[240:241], v[16:17], v[208:209], v[80:81] op_sel_hi:[0,1,1]
    v_pk_mul_f32 v[242:243], v[240:241], v[20:21] op_sel_hi:[1,0]
    v_pk_fma_f32 v[244:245], v[240:241], v[18:19], 1.0 op_sel_hi:[1,0,0]
    v_exp_f32_e64 v242, v242 clamp
    v_exp_f32_e64 v243, v243 clamp
    v_max_f32 v244, v244, v242
    v_max_f32 v245, v245, v243
    v_pk_add_f32 v[244:245], v[244:245], s[46:47]
    v_cvt_pk_bf16_f32 v40, v244, v245
    v_pk_fma_f32 v[246:247], v[16:17], v[210:211], v[82:83] op_sel_hi:[0,1,1]
    v_pk_mul_f32 v[248:249], v[246:247], v[20:21] op_sel_hi:[1,0]
    v_pk_fma_f32 v[250:251], v[246:247], v[18:19], 1.0 op_sel_hi:[1,0,0]
    v_exp_f32_e64 v248, v248 clamp
    v_exp_f32_e64 v249, v249 clamp
    v_max_f32 v250, v250, v248
    v_max_f32 v251, v251, v249
    v_pk_add_f32 v[250:251], v[250:251], s[46:47]
    v_cvt_pk_bf16_f32 v41, v250, v251
    v_pk_fma_f32 v[240:241], v[16:17], v[212:213], v[84:85] op_sel_hi:[0,1,1]
    v_pk_mul_f32 v[242:243], v[240:241], v[20:21] op_sel_hi:[1,0]
    v_pk_fma_f32 v[244:245], v[240:241], v[18:19], 1.0 op_sel_hi:[1,0,0]
    v_exp_f32_e64 v242, v242 clamp
    v_exp_f32_e64 v243, v243 clamp
    v_max_f32 v244, v244, v242
    v_max_f32 v245, v245, v243
    v_pk_add_f32 v[244:245], v[244:245], s[46:47]
    v_cvt_pk_bf16_f32 v42, v244, v245
    v_pk_fma_f32 v[246:247], v[16:17], v[214:215], v[86:87] op_sel_hi:[0,1,1]
    v_pk_mul_f32 v[248:249], v[246:247], v[20:21] op_sel_hi:[1,0]
    v_pk_fma_f32 v[250:251], v[246:247], v[18:19], 1.0 op_sel_hi:[1,0,0]
    v_exp_f32_e64 v248, v248 clamp
    v_exp_f32_e64 v249, v249 clamp
    v_max_f32 v250, v250, v248
    v_max_f32 v251, v251, v249
    v_pk_add_f32 v[250:251], v[250:251], s[46:47]
    v_cvt_pk_bf16_f32 v43, v250, v251
    buffer_store_dwordx4 v[40:43], v12, s[20:23], s49 offen offset:0 sc1
    v_pk_fma_f32 v[240:241], v[16:17], v[216:217], v[88:89] op_sel_hi:[0,1,1]
    v_pk_mul_f32 v[242:243], v[240:241], v[20:21] op_sel_hi:[1,0]
    v_pk_fma_f32 v[244:245], v[240:241], v[18:19], 1.0 op_sel_hi:[1,0,0]
    v_exp_f32_e64 v242, v242 clamp
    v_exp_f32_e64 v243, v243 clamp
    v_max_f32 v244, v244, v242
    v_max_f32 v245, v245, v243
    v_pk_add_f32 v[244:245], v[244:245], s[46:47]
    v_cvt_pk_bf16_f32 v44, v244, v245
    v_pk_fma_f32 v[246:247], v[16:17], v[218:219], v[90:91] op_sel_hi:[0,1,1]
    v_pk_mul_f32 v[248:249], v[246:247], v[20:21] op_sel_hi:[1,0]
    v_pk_fma_f32 v[250:251], v[246:247], v[18:19], 1.0 op_sel_hi:[1,0,0]
    v_exp_f32_e64 v248, v248 clamp
    v_exp_f32_e64 v249, v249 clamp
    v_max_f32 v250, v250, v248
    v_max_f32 v251, v251, v249
    v_pk_add_f32 v[250:251], v[250:251], s[46:47]
    v_cvt_pk_bf16_f32 v45, v250, v251
    v_pk_fma_f32 v[240:241], v[16:17], v[220:221], v[92:93] op_sel_hi:[0,1,1]
    v_pk_mul_f32 v[242:243], v[240:241], v[20:21] op_sel_hi:[1,0]
    v_pk_fma_f32 v[244:245], v[240:241], v[18:19], 1.0 op_sel_hi:[1,0,0]
    v_exp_f32_e64 v242, v242 clamp
    v_exp_f32_e64 v243, v243 clamp
    v_max_f32 v244, v244, v242
    v_max_f32 v245, v245, v243
    v_pk_add_f32 v[244:245], v[244:245], s[46:47]
    v_cvt_pk_bf16_f32 v46, v244, v245
    v_pk_fma_f32 v[246:247], v[16:17], v[222:223], v[94:95] op_sel_hi:[0,1,1]
    v_pk_mul_f32 v[248:249], v[246:247], v[20:21] op_sel_hi:[1,0]
    v_pk_fma_f32 v[250:251], v[246:247], v[18:19], 1.0 op_sel_hi:[1,0,0]
    v_exp_f32_e64 v248, v248 clamp
    v_exp_f32_e64 v249, v249 clamp
    v_max_f32 v250, v250, v248
    v_max_f32 v251, v251, v249
    v_pk_add_f32 v[250:251], v[250:251], s[46:47]
    v_cvt_pk_bf16_f32 v47, v250, v251
    buffer_store_dwordx4 v[44:47], v12, s[20:23], s49 offen offset:1024 sc1
    s_add_u32 s49, s43, 32768
    v_pk_fma_f32 v[240:241], v[22:23], v[192:193], v[96:97] op_sel_hi:[0,1,1]
    v_pk_mul_f32 v[242:243], v[240:241], v[26:27] op_sel_hi:[1,0]
    v_pk_fma_f32 v[244:245], v[240:241], v[24:25], 1.0 op_sel_hi:[1,0,0]
    v_exp_f32_e64 v242, v242 clamp
    v_exp_f32_e64 v243, v243 clamp
    v_max_f32 v244, v244, v242
    v_max_f32 v245, v245, v243
    v_pk_add_f32 v[244:245], v[244:245], s[46:47]
    v_cvt_pk_bf16_f32 v48, v244, v245
    v_pk_fma_f32 v[246:247], v[22:23], v[194:195], v[98:99] op_sel_hi:[0,1,1]
    v_pk_mul_f32 v[248:249], v[246:247], v[26:27] op_sel_hi:[1,0]
    v_pk_fma_f32 v[250:251], v[246:247], v[24:25], 1.0 op_sel_hi:[1,0,0]
    v_exp_f32_e64 v248, v248 clamp
    v_exp_f32_e64 v249, v249 clamp
    v_max_f32 v250, v250, v248
    v_max_f32 v251, v251, v249
    v_pk_add_f32 v[250:251], v[250:251], s[46:47]
    v_cvt_pk_bf16_f32 v49, v250, v251
    v_pk_fma_f32 v[240:241], v[22:23], v[196:197], v[100:101] op_sel_hi:[0,1,1]
    v_pk_mul_f32 v[242:243], v[240:241], v[26:27] op_sel_hi:[1,0]
    v_pk_fma_f32 v[244:245], v[240:241], v[24:25], 1.0 op_sel_hi:[1,0,0]
    v_exp_f32_e64 v242, v242 clamp
    v_exp_f32_e64 v243, v243 clamp
    v_max_f32 v244, v244, v242
    v_max_f32 v245, v245, v243
    v_pk_add_f32 v[244:245], v[244:245], s[46:47]
    v_cvt_pk_bf16_f32 v50, v244, v245
    v_pk_fma_f32 v[246:247], v[22:23], v[198:199], v[102:103] op_sel_hi:[0,1,1]
    v_pk_mul_f32 v[248:249], v[246:247], v[26:27] op_sel_hi:[1,0]
    v_pk_fma_f32 v[250:251], v[246:247], v[24:25], 1.0 op_sel_hi:[1,0,0]
    v_exp_f32_e64 v248, v248 clamp
    v_exp_f32_e64 v249, v249 clamp
    v_max_f32 v250, v250, v248
    v_max_f32 v251, v251, v249
    v_pk_add_f32 v[250:251], v[250:251], s[46:47]
    v_cvt_pk_bf16_f32 v51, v250, v251
    buffer_store_dwordx4 v[48:51], v12, s[20:23], s49 offen offset:0 sc1
    v_pk_fma_f32 v[240:241], v[22:23], v[200:201], v[104:105] op_sel_hi:[0,1,1]
    v_pk_mul_f32 v[242:243], v[240:241], v[26:27] op_sel_hi:[1,0]
    v_pk_fma_f32 v[244:245], v[240:241], v[24:25], 1.0 op_sel_hi:[1,0,0]
    v_exp_f32_e64 v242, v242 clamp
    v_exp_f32_e64 v243, v243 clamp
    v_max_f32 v244, v244, v242
    v_max_f32 v245, v245, v243
    v_pk_add_f32 v[244:245], v[244:245], s[46:47]
    v_cvt_pk_bf16_f32 v52, v244, v245
    v_pk_fma_f32 v[246:247], v[22:23], v[202:203], v[106:107] op_sel_hi:[0,1,1]
    v_pk_mul_f32 v[248:249], v[246:247], v[26:27] op_sel_hi:[1,0]
    v_pk_fma_f32 v[250:251], v[246:247], v[24:25], 1.0 op_sel_hi:[1,0,0]
    v_exp_f32_e64 v248, v248 clamp
    v_exp_f32_e64 v249, v249 clamp
    v_max_f32 v250, v250, v248
    v_max_f32 v251, v251, v249
    v_pk_add_f32 v[250:251], v[250:251], s[46:47]
    v_cvt_pk_bf16_f32 v53, v250, v251
    v_pk_fma_f32 v[240:241], v[22:23], v[204:205], v[108:109] op_sel_hi:[0,1,1]
    v_pk_mul_f32 v[242:243], v[240:241], v[26:27] op_sel_hi:[1,0]
    v_pk_fma_f32 v[244:245], v[240:241], v[24:25], 1.0 op_sel_hi:[1,0,0]
    v_exp_f32_e64 v242, v242 clamp
    v_exp_f32_e64 v243, v243 clamp
    v_max_f32 v244, v244, v242
    v_max_f32 v245, v245, v243
    v_pk_add_f32 v[244:245], v[244:245], s[46:47]
    v_cvt_pk_bf16_f32 v54, v244, v245
    v_pk_fma_f32 v[246:247], v[22:23], v[206:207], v[110:111] op_sel_hi:[0,1,1]
    v_pk_mul_f32 v[248:249], v[246:247], v[26:27] op_sel_hi:[1,0]
    v_pk_fma_f32 v[250:251], v[246:247], v[24:25], 1.0 op_sel_hi:[1,0,0]
    v_exp_f32_e64 v248, v248 clamp
    v_exp_f32_e64 v249, v249 clamp
    v_max_f32 v250, v250, v248
    v_max_f32 v251, v251, v249
    v_pk_add_f32 v[250:251], v[250:251], s[46:47]
    v_cvt_pk_bf16_f32 v55, v250, v251
    buffer_store_dwordx4 v[52:55], v12, s[20:23], s49 offen offset:1024 sc1
    s_add_u32 s49, s43, 36864
    v_pk_fma_f32 v[240:241], v[22:23], v[208:209], v[112:113] op_sel_hi:[0,1,1]
    v_pk_mul_f32 v[242:243], v[240:241], v[26:27] op_sel_hi:[1,0]
    v_pk_fma_f32 v[244:245], v[240:241], v[24:25], 1.0 op_sel_hi:[1,0,0]
    v_exp_f32_e64 v242, v242 clamp
    v_exp_f32_e64 v243, v243 clamp
    v_max_f32 v244, v244, v242
    v_max_f32 v245, v245, v243
    v_pk_add_f32 v[244:245], v[244:245], s[46:47]
    v_cvt_pk_bf16_f32 v56, v244, v245
    v_pk_fma_f32 v[246:247], v[22:23], v[210:211], v[114:115] op_sel_hi:[0,1,1]
    v_pk_mul_f32 v[248:249], v[246:247], v[26:27] op_sel_hi:[1,0]
    v_pk_fma_f32 v[250:251], v[246:247], v[24:25], 1.0 op_sel_hi:[1,0,0]
    v_exp_f32_e64 v248, v248 clamp
    v_exp_f32_e64 v249, v249 clamp
    v_max_f32 v250, v250, v248
    v_max_f32 v251, v251, v249
    v_pk_add_f32 v[250:251], v[250:251], s[46:47]
    v_cvt_pk_bf16_f32 v57, v250, v251
    v_pk_fma_f32 v[240:241], v[22:23], v[212:213], v[116:117] op_sel_hi:[0,1,1]
    v_pk_mul_f32 v[242:243], v[240:241], v[26:27] op_sel_hi:[1,0]
    v_pk_fma_f32 v[244:245], v[240:241], v[24:25], 1.0 op_sel_hi:[1,0,0]
    v_exp_f32_e64 v242, v242 clamp
    v_exp_f32_e64 v243, v243 clamp
    v_max_f32 v244, v244, v242
    v_max_f32 v245, v245, v243
    v_pk_add_f32 v[244:245], v[244:245], s[46:47]
    v_cvt_pk_bf16_f32 v58, v244, v245
    v_pk_fma_f32 v[246:247], v[22:23], v[214:215], v[118:119] op_sel_hi:[0,1,1]
    v_pk_mul_f32 v[248:249], v[246:247], v[26:27] op_sel_hi:[1,0]
    v_pk_fma_f32 v[250:251], v[246:247], v[24:25], 1.0 op_sel_hi:[1,0,0]
    v_exp_f32_e64 v248, v248 clamp
    v_exp_f32_e64 v249, v249 clamp
    v_max_f32 v250, v250, v248
    v_max_f32 v251, v251, v249
    v_pk_add_f32 v[250:251], v[250:251], s[46:47]
    v_cvt_pk_bf16_f32 v59, v250, v251
    buffer_store_dwordx4 v[56:59], v12, s[20:23], s49 offen offset:0 sc1
    v_pk_fma_f32 v[240:241], v[22:23], v[216:217], v[120:121] op_sel_hi:[0,1,1]
    v_pk_mul_f32 v[242:243], v[240:241], v[26:27] op_sel_hi:[1,0]
    v_pk_fma_f32 v[244:245], v[240:241], v[24:25], 1.0 op_sel_hi:[1,0,0]
    v_exp_f32_e64 v242, v242 clamp
    v_exp_f32_e64 v243, v243 clamp
    v_max_f32 v244, v244, v242
    v_max_f32 v245, v245, v243
    v_pk_add_f32 v[244:245], v[244:245], s[46:47]
    v_cvt_pk_bf16_f32 v60, v244, v245
    v_pk_fma_f32 v[246:247], v[22:23], v[218:219], v[122:123] op_sel_hi:[0,1,1]
    v_pk_mul_f32 v[248:249], v[246:247], v[26:27] op_sel_hi:[1,0]
    v_pk_fma_f32 v[250:251], v[246:247], v[24:25], 1.0 op_sel_hi:[1,0,0]
    v_exp_f32_e64 v248, v248 clamp
    v_exp_f32_e64 v249, v249 clamp
    v_max_f32 v250, v250, v248
    v_max_f32 v251, v251, v249
    v_pk_add_f32 v[250:251], v[250:251], s[46:47]
    v_cvt_pk_bf16_f32 v61, v250, v251
    v_pk_fma_f32 v[240:241], v[22:23], v[220:221], v[124:125] op_sel_hi:[0,1,1]
    v_pk_mul_f32 v[242:243], v[240:241], v[26:27] op_sel_hi:[1,0]
    v_pk_fma_f32 v[244:245], v[240:241], v[24:25], 1.0 op_sel_hi:[1,0,0]
    v_exp_f32_e64 v242, v242 clamp
    v_exp_f32_e64 v243, v243 clamp
    v_max_f32 v244, v244, v242
    v_max_f32 v245, v245, v243
    v_pk_add_f32 v[244:245], v[244:245], s[46:47]
    v_cvt_pk_bf16_f32 v62, v244, v245
    v_pk_fma_f32 v[246:247], v[22:23], v[222:223], v[126:127] op_sel_hi:[0,1,1]
    v_pk_mul_f32 v[248:249], v[246:247], v[26:27] op_sel_hi:[1,0]
    v_pk_fma_f32 v[250:251], v[246:247], v[24:25], 1.0 op_sel_hi:[1,0,0]
    v_exp_f32_e64 v248, v248 clamp
    v_exp_f32_e64 v249, v249 clamp
    v_max_f32 v250, v250, v248
    v_max_f32 v251, v251, v249
    v_pk_add_f32 v[250:251], v[250:251], s[46:47]
    v_cvt_pk_bf16_f32 v63, v250, v251
    buffer_store_dwordx4 v[60:63], v12, s[20:23], s49 offen offset:1024 sc1
    s_branch L_A_end
L_Aload1:
    s_sub_u32 s41, s28, 4
    s_lshl_b32 s33, s38, 1
    s_add_u32 s33, s33, s30
    s_add_u32 s33, s33, s36
    s_and_b32 s53, s33, 0
    v_lshrrev_b32 v10, 4, v1
    v_and_b32 v11, 15, v1
    v_lshlrev_b32 v12, 2, v10
    v_xor_b32 v11, v11, v12
    s_lshl_b32 s43, s41, 4
    v_add_u32 v12, s43, v10
    s_lshl_b32 s50, s34, 7
    s_add_u32 s50, s50, 1024
    s_lshl_b32 s52, s35, 8
    s_cmp_ge_u32 s30, 4
    s_cselect_b32 s49, 0, 896
    s_cselect_b32 s50, s52, s50
    v_lshrrev_b32 v13, 3, v11
    v_mul_u32_u24 v13, s49, v13
    v_lshl_add_u32 v13, v11, 4, v13
    v_mul_u32_u24 v6, 3072, v12
    v_add_u32 v6, v6, v13
    v_add_u32 v7, 11264, v6
    v_add_u32 v8, 22528, v6
    v_add_u32 v9, 33792, v6
    s_lshl_b32 s52, s41, 12
    v_lshlrev_b32 v14, 12, v12
    v_lshl_add_u32 v14, v11, 4, v14
    v_add_u32 v4, 30720, v14
    v_add_u32 v5, 46080, v14
    s_lshl_b32 s51, s29, 8
    s_add_u32 s51, s51, 0x880000
    v_mov_b32 v2, v14
    v_add_u32 v3, 15360, v14
    s_add_u32 s55, s53, 0
    s_and_b32 s55, s55, 7
    s_mul_i32 s55, s55, 196608
    s_add_u32 m0, s52, 65536
    s_add_u32 s55, s55, s50
    buffer_load_dwordx4 v6, s[16:19], s55 offen offset:0 lds
    buffer_load_dwordx4 v7, s[16:19], s55 offen offset:1024 lds
    buffer_load_dwordx4 v8, s[16:19], s55 offen offset:2048 lds
    buffer_load_dwordx4 v9, s[16:19], s55 offen offset:3072 lds
    s_add_u32 s55, s53, 1
    s_and_b32 s55, s55, 7
    s_mul_i32 s55, s55, 196608
    s_add_u32 m0, s52, 81920
    s_add_u32 s55, s55, s50
    buffer_load_dwordx4 v6, s[16:19], s55 offen offset:0 lds
    buffer_load_dwordx4 v7, s[16:19], s55 offen offset:1024 lds
    buffer_load_dwordx4 v8, s[16:19], s55 offen offset:2048 lds
    buffer_load_dwordx4 v9, s[16:19], s55 offen offset:3072 lds
    s_add_u32 s55, s53, 2
    s_and_b32 s55, s55, 7
    s_mul_i32 s55, s55, 196608
    s_add_u32 m0, s52, 98304
    s_add_u32 s55, s55, s50
    buffer_load_dwordx4 v6, s[16:19], s55 offen offset:0 lds
    buffer_load_dwordx4 v7, s[16:19], s55 offen offset:1024 lds
    buffer_load_dwordx4 v8, s[16:19], s55 offen offset:2048 lds
    buffer_load_dwordx4 v9, s[16:19], s55 offen offset:3072 lds
    s_add_u32 s55, s53, 3
    s_and_b32 s55, s55, 7
    s_mul_i32 s55, s55, 196608
    s_add_u32 m0, s52, 114688
    s_add_u32 s55, s55, s50
    buffer_load_dwordx4 v6, s[16:19], s55 offen offset:0 lds
    buffer_load_dwordx4 v7, s[16:19], s55 offen offset:1024 lds
    buffer_load_dwordx4 v8, s[16:19], s55 offen offset:2048 lds
    buffer_load_dwordx4 v9, s[16:19], s55 offen offset:3072 lds
    s_barrier
    s_add_u32 s54, s53, 0
    s_and_b32 s54, s54, 7
    s_lshl_b32 s54, s54, 18
    s_add_u32 m0, s52, 0
    s_add_u32 s54, s54, s51
    buffer_load_dwordx4 v2, s[20:23], s54 offen offset:0 sc1 lds
    buffer_load_dwordx4 v3, s[20:23], s54 offen offset:1024 sc1 lds
    buffer_load_dwordx4 v4, s[20:23], s54 offen offset:2048 sc1 lds
    buffer_load_dwordx4 v5, s[20:23], s54 offen offset:3072 sc1 lds
    s_add_u32 s54, s53, 1
    s_and_b32 s54, s54, 7
    s_lshl_b32 s54, s54, 18
    s_add_u32 m0, s52, 16384
    s_add_u32 s54, s54, s51
    buffer_load_dwordx4 v2, s[20:23], s54 offen offset:0 sc1 lds
    buffer_load_dwordx4 v3, s[20:23], s54 offen offset:1024 sc1 lds
    buffer_load_dwordx4 v4, s[20:23], s54 offen offset:2048 sc1 lds
    buffer_load_dwordx4 v5, s[20:23], s54 offen offset:3072 sc1 lds
    s_add_u32 s54, s53, 2
    s_and_b32 s54, s54, 7
    s_lshl_b32 s54, s54, 18
    s_add_u32 m0, s52, 32768
    s_add_u32 s54, s54, s51
    buffer_load_dwordx4 v2, s[20:23], s54 offen offset:0 sc1 lds
    buffer_load_dwordx4 v3, s[20:23], s54 offen offset:1024 sc1 lds
    buffer_load_dwordx4 v4, s[20:23], s54 offen offset:2048 sc1 lds
    buffer_load_dwordx4 v5, s[20:23], s54 offen offset:3072 sc1 lds
    s_add_u32 s54, s53, 3
    s_and_b32 s54, s54, 7
    s_lshl_b32 s54, s54, 18
    s_add_u32 m0, s52, 49152
    s_add_u32 s54, s54, s51
    buffer_load_dwordx4 v2, s[20:23], s54 offen offset:0 sc1 lds
    buffer_load_dwordx4 v3, s[20:23], s54 offen offset:1024 sc1 lds
    buffer_load_dwordx4 v4, s[20:23], s54 offen offset:2048 sc1 lds
    buffer_load_dwordx4 v5, s[20:23], s54 offen offset:3072 sc1 lds
    v_lshlrev_b32 v21, 4, v1
    v_and_b32 v19, 15, v1
    v_lshlrev_b32 v19, 8, v19
    v_add_u32 v19, 0xeb2000, v19
    s_lshl_b32 s58, s29, 1
    s_add_u32 s58, s58, s41
    s_lshl_b32 s58, s58, 11
    s_add_u32 s58, s58, 0x850000
    s_and_b32 s59, s41, 1
    s_add_u32 s43, s49, 128
    s_mul_i32 s59, s59, s43
    s_add_u32 s59, s59, s50
    s_lshl_b32 s59, s59, 4
    s_add_u32 s59, s59, 0xea0000
    s_cmp_ge_u32 s41, 2
    s_cselect_b32 s58, s59, s58
    s_waitcnt vmcnt(12)
    s_barrier
    s_waitcnt vmcnt(8)
    s_barrier
    s_add_u32 s54, s53, 4
    s_and_b32 s54, s54, 7
    s_lshl_b32 s54, s54, 18
    s_add_u32 m0, s52, 0
    s_add_u32 s54, s54, s51
    buffer_load_dwordx4 v2, s[20:23], s54 offen offset:0 sc1 lds
    buffer_load_dwordx4 v3, s[20:23], s54 offen offset:1024 sc1 lds
    buffer_load_dwordx4 v4, s[20:23], s54 offen offset:2048 sc1 lds
    buffer_load_dwordx4 v5, s[20:23], s54 offen offset:3072 sc1 lds
    s_add_u32 s55, s53, 4
    s_and_b32 s55, s55, 7
    s_mul_i32 s55, s55, 196608
    s_add_u32 m0, s52, 65536
    s_add_u32 s55, s55, s50
    buffer_load_dwordx4 v6, s[16:19], s55 offen offset:0 lds
    buffer_load_dwordx4 v7, s[16:19], s55 offen offset:1024 lds
    buffer_load_dwordx4 v8, s[16:19], s55 offen offset:2048 lds
    buffer_load_dwordx4 v9, s[16:19], s55 offen offset:3072 lds
    s_waitcnt vmcnt(12)
    s_barrier
    s_add_u32 s54, s53, 5
    s_and_b32 s54, s54, 7
    s_lshl_b32 s54, s54, 18
    s_add_u32 m0, s52, 16384
    s_add_u32 s54, s54, s51
    buffer_load_dwordx4 v2, s[20:23], s54 offen offset:0 sc1 lds
    buffer_load_dwordx4 v3, s[20:23], s54 offen offset:1024 sc1 lds
    buffer_load_dwordx4 v4, s[20:23], s54 offen offset:2048 sc1 lds
    buffer_load_dwordx4 v5, s[20:23], s54 offen offset:3072 sc1 lds
    s_add_u32 s55, s53, 5
    s_and_b32 s55, s55, 7
    s_mul_i32 s55, s55, 196608
    s_add_u32 m0, s52, 81920
    s_add_u32 s55, s55, s50
    buffer_load_dwordx4 v6, s[16:19], s55 offen offset:0 lds
    buffer_load_dwordx4 v7, s[16:19], s55 offen offset:1024 lds
    buffer_load_dwordx4 v8, s[16:19], s55 offen offset:2048 lds
    buffer_load_dwordx4 v9, s[16:19], s55 offen offset:3072 lds
    s_waitcnt vmcnt(16)
    s_barrier
    s_add_u32 s54, s53, 6
    s_and_b32 s54, s54, 7
    s_lshl_b32 s54, s54, 18
    s_add_u32 m0, s52, 32768
    s_add_u32 s54, s54, s51
    buffer_load_dwordx4 v2, s[20:23], s54 offen offset:0 sc1 lds
    buffer_load_dwordx4 v3, s[20:23], s54 offen offset:1024 sc1 lds
    buffer_load_dwordx4 v4, s[20:23], s54 offen offset:2048 sc1 lds
    buffer_load_dwordx4 v5, s[20:23], s54 offen offset:3072 sc1 lds
    s_add_u32 s55, s53, 6
    s_and_b32 s55, s55, 7
    s_mul_i32 s55, s55, 196608
    s_add_u32 m0, s52, 98304
    s_add_u32 s55, s55, s50
    buffer_load_dwordx4 v6, s[16:19], s55 offen offset:0 lds
    buffer_load_dwordx4 v7, s[16:19], s55 offen offset:1024 lds
    buffer_load_dwordx4 v8, s[16:19], s55 offen offset:2048 lds
    buffer_load_dwordx4 v9, s[16:19], s55 offen offset:3072 lds
    s_waitcnt vmcnt(16)
    s_barrier
    s_add_u32 s54, s53, 7
    s_and_b32 s54, s54, 7
    s_lshl_b32 s54, s54, 18
    s_add_u32 m0, s52, 49152
    s_add_u32 s54, s54, s51
    buffer_load_dwordx4 v2, s[20:23], s54 offen offset:0 sc1 lds
    buffer_load_dwordx4 v3, s[20:23], s54 offen offset:1024 sc1 lds
    buffer_load_dwordx4 v4, s[20:23], s54 offen offset:2048 sc1 lds
    buffer_load_dwordx4 v5, s[20:23], s54 offen offset:3072 sc1 lds
    s_add_u32 s55, s53, 7
    s_and_b32 s55, s55, 7
    s_mul_i32 s55, s55, 196608
    s_add_u32 m0, s52, 114688
    s_add_u32 s55, s55, s50
    buffer_load_dwordx4 v6, s[16:19], s55 offen offset:0 lds
    buffer_load_dwordx4 v7, s[16:19], s55 offen offset:1024 lds
    buffer_load_dwordx4 v8, s[16:19], s55 offen offset:2048 lds
    buffer_load_dwordx4 v9, s[16:19], s55 offen offset:3072 lds
    s_waitcnt vmcnt(16)
    s_barrier
    s_waitcnt vmcnt(8)
    s_barrier
    buffer_load_dwordx4 v[24:27], v21, s[20:23], s58 offen offset:0 sc1
    buffer_load_dwordx4 v[28:31], v21, s[20:23], s58 offen offset:1024 sc1
    s_waitcnt vmcnt(2)
    s_barrier
    s_lshl_b32 s43, s41, 8
    s_add_u32 s43, s43, 131072
    v_lshl_add_u32 v18, v1, 2, s43
    s_mov_b32 s57, 0
    s_waitcnt lgkmcnt(0)
    s_add_u32 s6, s6, 0
L_pchk_A1:
    s_waitcnt vmcnt(0)
    v_xor_b32 v22, s6, v25
    v_xor_b32 v23, s6, v27
    v_or_b32 v22, v22, v23
    v_xor_b32 v23, s6, v29
    v_or_b32 v22, v22, v23
    v_xor_b32 v23, s6, v31
    v_or_b32 v22, v22, v23
    v_cmp_ne_u32 vcc, 0, v22
    s_cbranch_vccz L_pok_A1
    s_add_u32 s57, s57, 1
    s_cmp_gt_u32 s57, 200000
    s_cbranch_scc1 L_pok_A1
    s_sleep 4
    buffer_load_dwordx4 v[24:27], v21, s[20:23], s58 offen offset:0 sc1
    buffer_load_dwordx4 v[28:31], v21, s[20:23], s58 offen offset:1024 sc1
    s_branch L_pchk_A1
L_pok_A1:
    v_add_f32 v22, v24, v28
    v_add_f32 v23, v26, v30
    s_cmp_ge_u32 s41, 2
    s_cbranch_scc1 L_lcs_A1
    v_mul_f32 v22, 0xbb000000, v22
    v_mul_f32 v24, v22, v22
    v_mov_b32 v25, 0x3b000000
    v_fma_f32 v23, v23, v25, -v24
    v_max_f32 v23, 0, v23
    v_add_f32 v23, 0x3727c5ac, v23
    v_rsq_f32 v23, v23
    ds_write_b32 v18, v22
    v_mul_f32 v24, 0x3fb8aa3b, v23
    ds_write_b32 v18, v23 offset:512
    ds_write_b32 v18, v24 offset:1024
    s_branch L_lcs2_A1
L_lcs_A1:
    ds_write_b32 v18, v22 offset:1024
L_lcs2_A1:
    s_waitcnt lgkmcnt(0)
    s_barrier
    s_branch L_Altail
L_Altail:
    s_mov_b32 s56, s30
    s_mov_b32 s57, s34
    s_lshl_b32 s29, s36, 2
    s_and_b32 s38, s37, 3
    s_add_u32 s29, s29, s38
    s_lshr_b32 s30, s37, 2
    s_and_b32 s41, s28, 3
    s_lshr_b32 s42, s41, 1
    s_and_b32 s43, s41, 1
    v_lshrrev_b32 v8, 3, v1
    v_and_b32 v9, 7, v1
    v_bfe_u32 v10, v1, 4, 1
    v_lshlrev_b32 v10, 2, v10
    v_xor_b32 v10, v9, v10
    v_lshlrev_b32 v10, 4, v10
    v_lshl_add_u32 v12, v8, 10, v10
    v_add_u32 v13, 7168, v12
    v_add_u32 v14, 14336, v12
    v_add_u32 v15, 21504, v12
    s_lshl_b32 s50, s41, 17
    s_lshl_b32 s49, s30, 7
    s_add_u32 s50, s50, s49
    s_lshl_b32 s51, s41, 14
    s_mov_b32 s52, 0
L_shb_2:
    s_add_u32 s44, s52, s38
    s_and_b32 s44, s44, 3
    s_lshl_b32 s45, s44, 15
    s_add_u32 s45, s45, s50
    s_lshl_b32 s44, s44, 12
    s_add_u32 m0, s44, s51
    s_add_u32 s52, s52, 1
    buffer_load_dwordx4 v12, s[60:63], s45 offen offset:0 lds
    buffer_load_dwordx4 v13, s[60:63], s45 offen offset:1024 lds
    buffer_load_dwordx4 v14, s[60:63], s45 offen offset:2048 lds
    buffer_load_dwordx4 v15, s[60:63], s45 offen offset:3072 lds
    s_cmp_lt_u32 s52, 4
    s_cbranch_scc1 L_shb_2
    s_lshl_b32 s44, s41, 11
    s_add_u32 m0, s44, 148480
    s_cmp_lg_u32 s68, 0
    s_cbranch_scc1 L_shb1_2
    v_lshrrev_b32 v11, 4, v1
    v_xor_b32 v11, v9, v11
    v_lshlrev_b32 v11, 4, v11
    v_lshl_add_u32 v16, v8, 10, v11
    v_xor_b32 v17, 64, v16
    v_add_u32 v17, 7168, v17
    s_lshl_b32 s48, s29, 16
    s_lshl_b32 s44, s41, 14
    s_add_u32 s48, s48, s44
    s_add_u32 s48, s48, s49
    buffer_load_dwordx4 v16, s[12:15], s48 offen lds
    buffer_load_dwordx4 v17, s[12:15], s48 offen offset:1024 lds
    s_branch L_shb2_2
L_shb1_2:
    v_lshl_add_u32 v16, v8, 12, v10
    v_add_u32 v17, 31744, v16
    s_lshl_b32 s48, s30, 18
    s_lshl_b32 s44, s41, 16
    s_add_u32 s48, s48, s44
    s_lshl_b32 s44, s29, 7
    s_add_u32 s48, s48, s44
    s_add_u32 s48, s48, 0x880000
    buffer_load_dwordx4 v16, s[20:23], s48 offen sc1 lds
    buffer_load_dwordx4 v17, s[20:23], s48 offen offset:1024 sc1 lds
L_shb2_2:
    s_cmp_ge_u32 s56, 4
    s_cbranch_scc1 L_A_end
    v_and_b32 v30, 255, v0
    v_lshlrev_b32 v30, 2, v30
    v_add_u32 v31, 133120, v30
    s_lshl_b32 s43, s57, 12
    s_add_u32 s43, s43, s68
    s_add_u32 s43, s43, 0x400000
    v_lshrrev_b32 v45, 5, v1
    v_and_b32 v44, 31, v1
    v_lshlrev_b32 v44, 2, v44
    v_lshl_add_u32 v44, v45, 8, v44
    v_add_u32 v44, 141312, v44
    s_barrier
    ds_read_b32 v32, v31 offset:0
    ds_read_b32 v33, v31 offset:4096
    ds_read_b32 v34, v31 offset:1024
    ds_read_b32 v35, v31 offset:5120
    ds_read_b32 v36, v31 offset:2048
    ds_read_b32 v37, v31 offset:6144
    ds_read_b32 v38, v31 offset:3072
    ds_read_b32 v39, v31 offset:7168
    s_waitcnt lgkmcnt(6)
    v_add_f32 v32, v32, v33
    buffer_atomic_add_f32 v32, v30, s[20:23], s43 offen offset:0
    s_waitcnt lgkmcnt(4)
    v_add_f32 v34, v34, v35
    buffer_atomic_add_f32 v34, v30, s[20:23], s43 offen offset:1024
    s_waitcnt lgkmcnt(2)
    v_add_f32 v36, v36, v37
    buffer_atomic_add_f32 v36, v30, s[20:23], s43 offen offset:2048
    s_waitcnt lgkmcnt(0)
    v_add_f32 v38, v38, v39
    buffer_atomic_add_f32 v38, v30, s[20:23], s43 offen offset:3072
    s_cmp_lg_u32 s28, 4
    s_cbranch_scc1 L_A_end
    ds_read_b32 v40, v44
    ds_read_b32 v41, v44 offset:128
    ds_read_b32 v42, v44 offset:512
    ds_read_b32 v43, v44 offset:640
    s_lshl_b32 s43, s57, 8
    s_add_u32 s43, s43, s68
    s_add_u32 s43, s43, 0x408000
    s_waitcnt lgkmcnt(0)
    v_add_f32 v40, v40, v41
    v_add_f32 v42, v42, v43
    v_add_f32 v40, v40, v42
    buffer_atomic_add_f32 v40, v30, s[20:23], s43 offen
    s_branch L_A_end
L_A_end:
    s_waitcnt vmcnt(0) lgkmcnt(0)
    s_barrier
    s_add_u32 s69, s69, 1
    s_cmp_lg_u32 s28, 7
    s_cbranch_scc1 L_arr0_A
    s_and_b32 s30, s2, 15
    s_lshl_b32 s30, s30, 8
    s_add_u32 s31, s30, 0xeb0000
    v_mov_b32 v2, 1
    v_mov_b32 v3, 0
    s_mov_b64 exec, 1
    buffer_atomic_add v2, v3, s[20:23], s31 offen sc0 sc1
    s_mov_b64 exec, -1
L_arr0_A:
    s_cmp_lg_u32 s28, 7
    s_cbranch_scc1 L_arr_A
    s_lshl_b32 s31, s69, 4
    s_sub_u32 s31, s31, 1
    s_waitcnt vmcnt(0)
    v_readfirstlane_b32 s32, v2
    s_nop 0
    s_cmp_lg_u32 s32, s31
    s_cbranch_scc1 L_arr_A
    v_mov_b32 v2, 1
    v_lshlrev_b32 v3, 8, v1
    s_mov_b32 s30, 0xec0000
    buffer_atomic_add v2, v3, s[20:23], s30 offen sc1
    s_mov_b64 exec, -1
L_arr_A:
L_B:
    s_lshl_b32 s30, s36, 7
    s_lshl_b32 s31, s37, 2
    s_add_u32 s30, s30, s31
    s_load_dword s3, s[4:5], s30
    s_lshl_b32 s29, s36, 2
    s_and_b32 s38, s37, 3
    s_add_u32 s29, s29, s38
    s_lshr_b32 s30, s37, 2
    s_and_b32 s41, s28, 3
    s_lshr_b32 s42, s41, 1
    s_and_b32 s43, s41, 1
    v_lshlrev_b32 v4, 4, v1
    s_cmp_lt_u32 s28, 4
    s_cbranch_scc1 L_Bmain
    s_lshl_b32 s54, s29, 16
    s_lshl_b32 s49, s41, 14
    s_add_u32 s54, s54, s49
    s_add_u32 s54, s54, s68
    s_add_u32 s55, s49, 65536
    v_and_b32 v52, 255, v0
    v_lshrrev_b32 v52, 3, v52
    v_and_b32 v53, 7, v1
    v_lshlrev_b32 v53, 4, v53
    v_mul_u32_u24 v54, 144, v52
    v_add_u32 v54, v54, v53
    v_lshl_add_u32 v55, v52, 12, v53
    s_lshl_b32 s44, s30, 18
    s_lshl_b32 s45, s29, 7
    s_add_u32 s44, s44, s45
    s_add_u32 s44, s44, s68
    s_add_u32 s44, s44, 0x200000
    s_add_u32 s45, s44, 131072
    s_mov_b32 m0, s55
    s_cmp_lg_u32 s28, 6
    s_cbranch_scc1 L_gw_B
    s_and_b32 s30, s2, 63
    s_lshl_b32 s30, s30, 8
    s_add_u32 s30, s30, 0xec0000
    s_mov_b32 s31, 0
    s_lshl_b32 s32, s69, 4
    v_mov_b32 v3, 0
    v_mov_b32 v2, 0
    s_mov_b64 exec, 1
    buffer_atomic_add v2, v3, s[20:23], s30 offen sc0 sc1
L_gp_B:
    v_mov_b32 v31, 0
    s_sleep 1
    buffer_atomic_add v31, v3, s[20:23], s30 offen sc0 sc1
    s_add_u32 s31, s31, 1
    s_waitcnt vmcnt(1)
    v_cmp_gt_u32 vcc, s32, v2
    s_cbranch_vccz L_gd_B
    v_mov_b32 v2, 0
    s_sleep 1
    buffer_atomic_add v2, v3, s[20:23], s30 offen sc0 sc1
    s_cmp_gt_u32 s31, 200000
    s_cbranch_scc1 L_gd_B
    s_waitcnt vmcnt(1)
    v_cmp_gt_u32 vcc, s32, v31
    s_cbranch_vccnz L_gp_B
L_gd_B:
    s_mov_b64 exec, -1
L_gw_B:
    s_barrier
    buffer_load_dwordx4 v4, s[20:23], s54 offen offset:0 sc1 lds
    buffer_load_dwordx4 v4, s[20:23], s54 offen offset:1024 sc1 lds
    buffer_load_dwordx4 v4, s[20:23], s54 offen offset:2048 sc1 lds
    buffer_load_dwordx4 v4, s[20:23], s54 offen offset:3072 sc1 lds
    s_add_u32 m0, s55, 4096
    s_add_u32 s54, s54, 4096
    buffer_load_dwordx4 v4, s[20:23], s54 offen offset:0 sc1 lds
    buffer_load_dwordx4 v4, s[20:23], s54 offen offset:1024 sc1 lds
    buffer_load_dwordx4 v4, s[20:23], s54 offen offset:2048 sc1 lds
    buffer_load_dwordx4 v4, s[20:23], s54 offen offset:3072 sc1 lds
    s_waitcnt vmcnt(4)
    s_barrier
    s_add_u32 m0, s55, 8192
    s_add_u32 s54, s54, 4096
    buffer_load_dwordx4 v4, s[20:23], s54 offen offset:0 sc1 lds
    buffer_load_dwordx4 v4, s[20:23], s54 offen offset:1024 sc1 lds
    buffer_load_dwordx4 v4, s[20:23], s54 offen offset:2048 sc1 lds
    buffer_load_dwordx4 v4, s[20:23], s54 offen offset:3072 sc1 lds
    s_add_u32 m0, s55, 12288
    s_add_u32 s54, s54, 4096
    buffer_load_dwordx4 v4, s[20:23], s54 offen offset:0 sc1 lds
    buffer_load_dwordx4 v4, s[20:23], s54 offen offset:1024 sc1 lds
    buffer_load_dwordx4 v4, s[20:23], s54 offen offset:2048 sc1 lds
    buffer_load_dwordx4 v4, s[20:23], s54 offen offset:3072 sc1 lds
    s_waitcnt vmcnt(8)
    s_barrier
    s_waitcnt vmcnt(4)
    s_barrier
    s_waitcnt vmcnt(0)
    s_barrier
    s_cmp_lt_u32 s37, 24
    s_cbranch_scc1 L_B_nkf
    s_xor_b32 s31, s28, 4
    s_or_b32 s31, s31, s68
    s_cmp_lg_u32 s31, 0
    s_cbranch_scc1 L_B_nkf
    s_sub_u32 s31, s37, 24
    s_lshl_b32 s31, s31, 3
    s_add_u32 s31, s31, s36
    s_lshl_b32 s31, s31, 7
    s_add_u32 s31, s31, 0xeb4000
    v_mov_b32 v2, s6
    v_mov_b32 v3, 0
    s_mov_b64 exec, 1
    buffer_store_dword v2, v3, s[20:23], s31 offen sc0 sc1
    s_mov_b64 exec, -1
L_B_nkf:
    s_barrier
    s_barrier
    ds_read_b128 v[56:59], v54 offset:0
    ds_read_b128 v[60:63], v54 offset:4608
    s_waitcnt lgkmcnt(1)
    buffer_store_dwordx4 v[56:59], v55, s[20:23], s44 offen sc1
    s_waitcnt lgkmcnt(0)
    buffer_store_dwordx4 v[60:63], v55, s[20:23], s45 offen sc1
    s_cmp_lg_u32 s28, 5
    s_cbranch_scc1 L_B_end
    s_cmp_lg_u32 s68, 0
    s_cbranch_scc1 L_B_end
    s_lshl_b32 s38, s36, 5
    s_and_b32 s39, s37, 28
    s_add_u32 s38, s38, s39
    s_lshl_b32 s38, s38, 5
    s_add_u32 s38, s38, 0xeb4000
    v_mov_b32 v8, 0
    s_mov_b32 s39, 0
L_C_kchk:
    buffer_load_dword v9, v8, s[20:23], s38 offen sc1
    s_add_u32 s39, s39, 1
    s_waitcnt vmcnt(0)
    v_cmp_ne_u32 vcc, s6, v9
    s_cmp_gt_u32 s39, 200000
    s_cbranch_scc1 L_C_kok
    s_cbranch_vccnz L_C_kchk
L_C_kok:
    s_branch L_B_end
L_Bmain:
    v_lshrrev_b32 v3, 5, v1
    v_and_b32 v5, 31, v1
    v_lshlrev_b32 v20, 4, v5
    v_lshl_add_u32 v21, v3, 10, v20
    v_lshlrev_b32 v22, 3, v1
    s_lshl_b32 s46, s41, 13
    s_add_u32 s46, s46, s68
    s_add_u32 s46, s46, 0x400000
    s_add_u32 s47, s46, 4096
    s_lshl_b32 s53, s41, 9
    s_add_u32 s53, s53, s68
    s_add_u32 s53, s53, 0x408000
    s_mul_i32 s49, s41, 4352
    s_add_u32 s49, s49, 131072
    v_mul_u32_u24 v18, 544, v3
    v_add3_u32 v18, v18, v20, s49
    v_lshrrev_b32 v8, 3, v1
    v_mul_u32_u24 v19, 544, v8
    v_bfe_u32 v20, v1, 1, 1
    v_lshl_add_u32 v19, v20, 4, v19
    v_and_b32 v20, 1, v1
    v_lshl_add_u32 v19, v20, 2, v19
    v_bfe_u32 v20, v1, 2, 1
    v_lshl_add_u32 v19, v20, 3, v19
    v_add_u32 v19, s49, v19
    v_bfe_u32 v2, v1, 2, 2
    v_bfe_u32 v23, v1, 4, 1
    v_and_b32 v6, 3, v1
    v_lshl_add_u32 v7, v3, 2, v2
    v_lshlrev_b32 v7, 7, v7
    v_lshl_add_u32 v7, v23, 5, v7
    v_lshl_add_u32 v7, v6, 3, v7
    v_lshrrev_b32 v8, 1, v2
    v_lshl_add_u32 v7, v8, 6, v7
    s_lshl_b32 s44, s43, 6
    v_xor_b32 v8, s44, v7
    s_lshl_b32 s44, s43, 15
    v_add_u32 v8, s44, v8
    v_xor_b32 v9, 64, v8
    v_and_b32 v10, 15, v1
    v_lshlrev_b32 v10, 4, v10
    v_lshl_add_u32 v10, v3, 8, v10
    v_lshlrev_b32 v11, 4, v3
    v_add_u32 v11, 512, v11
    v_cmp_eq_u32 vcc, 0, v23
    s_mul_i32 s44, s43, 8704
    s_add_u32 s44, s44, 131072
    v_cndmask_b32 v10, v11, v10, vcc
    v_add_u32 v10, s44, v10
    s_lshl_b32 s44, s41, 14
    s_add_u32 s44, s44, 65536
    v_add_u32 v11, s44, v4
    s_mov_b32 s48, 0x358637bd
    v_mul_u32_u24 v56, 576, v3
    v_lshl_add_u32 v56, v5, 1, v56
    s_mul_i32 s44, s43, 4608
    s_lshl_b32 s45, s42, 6
    s_add_u32 s44, s44, s45
    v_add_u32 v56, s44, v56
    v_lshlrev_b32 v57, 13, v3
    v_lshl_add_u32 v57, v5, 2, v57
    v_xor_b32 v58, 16384, v11
    s_lshl_b32 s50, s29, 8
    s_lshl_b32 s45, s42, 7
    s_add_u32 s50, s50, s45
    s_add_u32 s50, s50, s68
    s_add_u32 s50, s50, 0x409000
    v_bfe_u32 v12, v1, 1, 3
    s_lshl_b32 s44, s43, 2
    v_xor_b32 v12, s44, v12
    v_lshlrev_b32 v12, 4, v12
    v_lshl_add_u32 v12, v5, 7, v12
    v_lshl_add_u32 v12, v3, 3, v12
    s_lshl_b32 s44, s42, 12
    s_add_u32 s44, s44, 148480
    v_add_u32 v12, s44, v12
    v_xor_b32 v13, 16, v12
    v_xor_b32 v14, 32, v12
    v_xor_b32 v15, 48, v12
    s_lshl_b32 s44, s42, 6
    v_xor_b32 v6, s44, v7
    s_lshl_b32 s44, s43, 12
    s_add_u32 s44, s44, 148480
    v_add_u32 v6, s44, v6
    v_mov_b32 v144, 0
    v_mov_b32 v145, 0
    v_mov_b32 v146, 0
    v_mov_b32 v147, 0
    v_mov_b32 v148, 0
    v_mov_b32 v149, 0
    v_mov_b32 v150, 0
    v_mov_b32 v151, 0
    v_mov_b32 v152, 0
    v_mov_b32 v153, 0
    v_mov_b32 v154, 0
    v_mov_b32 v155, 0
    v_mov_b32 v156, 0
    v_mov_b32 v157, 0
    v_mov_b32 v158, 0
    v_mov_b32 v159, 0
    s_barrier
    buffer_load_dwordx4 v[64:67], v21, s[20:23], s46 offen offset:0 sc1
    buffer_load_dwordx4 v[68:71], v21, s[20:23], s46 offen offset:512 sc1
    buffer_load_dwordx4 v[72:75], v21, s[20:23], s46 offen offset:2048 sc1
    buffer_load_dwordx4 v[76:79], v21, s[20:23], s46 offen offset:2560 sc1
    buffer_load_dwordx4 v[80:83], v21, s[20:23], s47 offen offset:0 sc1
    buffer_load_dwordx4 v[84:87], v21, s[20:23], s47 offen offset:512 sc1
    buffer_load_dwordx4 v[88:91], v21, s[20:23], s47 offen offset:2048 sc1
    buffer_load_dwordx4 v[92:95], v21, s[20:23], s47 offen offset:2560 sc1
    buffer_load_dwordx2 v[62:63], v22, s[20:23], s53 offen sc1
    s_cmp_lg_u32 s68, 0
    s_cbranch_scc1 L_Bres1
    ds_read_b64 v[48:49], v12
    ds_read_b64 v[50:51], v13
    ds_read_b64 v[52:53], v14
    ds_read_b64 v[54:55], v15
    s_branch L_Bres2
L_Bres1:
    ds_read_b64_tr_b16 v[48:49], v6 offset:0
    ds_read_b64_tr_b16 v[50:51], v6 offset:1024
    ds_read_b64_tr_b16 v[52:53], v6 offset:2048
    ds_read_b64_tr_b16 v[54:55], v6 offset:3072
L_Bres2:
    s_waitcnt lgkmcnt(0)
    v_lshlrev_b32 v128, 16, v48
    v_and_b32 v129, 0xffff0000, v48
    v_lshlrev_b32 v130, 16, v49
    v_and_b32 v131, 0xffff0000, v49
    v_lshlrev_b32 v132, 16, v50
    v_and_b32 v133, 0xffff0000, v50
    v_lshlrev_b32 v134, 16, v51
    v_and_b32 v135, 0xffff0000, v51
    v_lshlrev_b32 v136, 16, v52
    v_and_b32 v137, 0xffff0000, v52
    v_lshlrev_b32 v138, 16, v53
    v_and_b32 v139, 0xffff0000, v53
    v_lshlrev_b32 v140, 16, v54
    v_and_b32 v141, 0xffff0000, v54
    v_lshlrev_b32 v142, 16, v55
    v_and_b32 v143, 0xffff0000, v55
    s_waitcnt vmcnt(7)
    v_cvt_pk_bf16_f32 v96, v64, v65
    v_cvt_pk_bf16_f32 v97, v66, v67
    v_cvt_pk_bf16_f32 v98, v68, v69
    v_cvt_pk_bf16_f32 v99, v70, v71
    ds_write_b128 v18, v[96:99] offset:0
    s_waitcnt vmcnt(5)
    v_cvt_pk_bf16_f32 v100, v72, v73
    v_cvt_pk_bf16_f32 v101, v74, v75
    v_cvt_pk_bf16_f32 v102, v76, v77
    v_cvt_pk_bf16_f32 v103, v78, v79
    ds_write_b128 v18, v[100:103] offset:1088
    s_waitcnt vmcnt(3)
    v_cvt_pk_bf16_f32 v104, v80, v81
    v_cvt_pk_bf16_f32 v105, v82, v83
    v_cvt_pk_bf16_f32 v106, v84, v85
    v_cvt_pk_bf16_f32 v107, v86, v87
    ds_write_b128 v18, v[104:107] offset:2176
    s_waitcnt vmcnt(1)
    v_cvt_pk_bf16_f32 v108, v88, v89
    v_cvt_pk_bf16_f32 v109, v90, v91
    v_cvt_pk_bf16_f32 v110, v92, v93
    v_cvt_pk_bf16_f32 v111, v94, v95
    ds_write_b128 v18, v[108:111] offset:3264
    s_waitcnt vmcnt(0)
    v_cvt_pk_bf16_f32 v62, v62, v63
    ds_write_b32 v19, v62 offset:512
    s_waitcnt lgkmcnt(0)
    s_barrier
    ds_read_b128 v[16:19], v10 offset:0
    ds_read_b128 v[24:27], v11 offset:0
    s_waitcnt lgkmcnt(0)
    v_mfma_f32_32x32x16_bf16 v[160:175], v[16:19], v[24:27], 0
    ds_read_b128 v[20:23], v10 offset:544
    ds_read_b128 v[28:31], v11 offset:1024
    s_waitcnt lgkmcnt(0)
    v_mfma_f32_32x32x16_bf16 v[176:191], v[20:23], v[28:31], 0
    ds_read_b128 v[16:19], v10 offset:1088
    ds_read_b128 v[24:27], v11 offset:2048
    ds_read_b64_tr_b16 v[32:33], v8 offset:0
    ds_read_b64_tr_b16 v[34:35], v8 offset:1024
    s_nop 3
    v_add_f32 v168, s48, v168
    v_rcp_f32 v168, v168
    ds_read_b64_tr_b16 v[36:37], v9 offset:0
    ds_read_b64_tr_b16 v[38:39], v9 offset:1024
    v_mul_f32 v160, v160, v168
    v_mul_f32 v161, v161, v168
    v_cvt_pk_bf16_f32 v64, v160, v161
    v_mul_f32 v162, v162, v168
    v_mul_f32 v163, v163, v168
    v_cvt_pk_bf16_f32 v65, v162, v163
    v_mul_f32 v164, v164, v168
    v_mul_f32 v165, v165, v168
    v_cvt_pk_bf16_f32 v66, v164, v165
    v_mul_f32 v166, v166, v168
    v_mul_f32 v167, v167, v168
    v_cvt_pk_bf16_f32 v67, v166, v167
    s_waitcnt lgkmcnt(0)
    v_mfma_f32_32x32x16_bf16 v[160:175], v[16:19], v[24:27], 0
    ds_read_b128 v[20:23], v10 offset:1632
    ds_read_b128 v[28:31], v11 offset:3072
    ds_read_b64_tr_b16 v[40:41], v8 offset:2048
    ds_read_b64_tr_b16 v[42:43], v8 offset:3072
    v_add_f32 v184, s48, v184
    v_rcp_f32 v184, v184
    v_mfma_f32_32x32x16_bf16 v[128:143], v[32:35], v[64:67], v[128:143]
    ds_read_b64_tr_b16 v[44:45], v9 offset:2048
    ds_read_b64_tr_b16 v[46:47], v9 offset:3072
    v_mul_f32 v176, v176, v184
    v_mul_f32 v177, v177, v184
    v_cvt_pk_bf16_f32 v68, v176, v177
    v_mul_f32 v178, v178, v184
    v_mul_f32 v179, v179, v184
    v_mfma_f32_32x32x16_bf16 v[144:159], v[36:39], v[64:67], v[144:159]
    v_cvt_pk_bf16_f32 v69, v178, v179
    v_mul_f32 v180, v180, v184
    v_mul_f32 v181, v181, v184
    v_cvt_pk_bf16_f32 v70, v180, v181
    v_mul_f32 v182, v182, v184
    v_mul_f32 v183, v183, v184
    v_cvt_pk_bf16_f32 v71, v182, v183
    s_waitcnt lgkmcnt(0)
    v_mfma_f32_32x32x16_bf16 v[176:191], v[20:23], v[28:31], 0
    s_barrier
    ds_read_b128 v[16:19], v10 offset:2176
    ds_read_b128 v[24:27], v11 offset:4096
    ds_read_b64_tr_b16 v[32:33], v8 offset:4096
    ds_read_b64_tr_b16 v[34:35], v8 offset:5120
    v_add_f32 v168, s48, v168
    v_rcp_f32 v168, v168
    v_mfma_f32_32x32x16_bf16 v[128:143], v[40:43], v[68:71], v[128:143]
    ds_read_b64_tr_b16 v[36:37], v9 offset:4096
    ds_read_b64_tr_b16 v[38:39], v9 offset:5120
    v_mul_f32 v160, v160, v168
    v_mul_f32 v161, v161, v168
    v_cvt_pk_bf16_f32 v64, v160, v161
    v_mul_f32 v162, v162, v168
    v_mul_f32 v163, v163, v168
    v_mfma_f32_32x32x16_bf16 v[144:159], v[44:47], v[68:71], v[144:159]
    v_cvt_pk_bf16_f32 v65, v162, v163
    v_mul_f32 v164, v164, v168
    v_mul_f32 v165, v165, v168
    v_cvt_pk_bf16_f32 v66, v164, v165
    v_mul_f32 v166, v166, v168
    v_mul_f32 v167, v167, v168
    v_cvt_pk_bf16_f32 v67, v166, v167
    s_waitcnt lgkmcnt(0)
    v_mfma_f32_32x32x16_bf16 v[160:175], v[16:19], v[24:27], 0
    ds_read_b128 v[20:23], v10 offset:2720
    ds_read_b128 v[28:31], v11 offset:5120
    ds_read_b64_tr_b16 v[40:41], v8 offset:6144
    ds_read_b64_tr_b16 v[42:43], v8 offset:7168
    v_add_f32 v184, s48, v184
    v_rcp_f32 v184, v184
    v_mfma_f32_32x32x16_bf16 v[128:143], v[32:35], v[64:67], v[128:143]
    ds_read_b64_tr_b16 v[44:45], v9 offset:6144
    ds_read_b64_tr_b16 v[46:47], v9 offset:7168
    v_mul_f32 v176, v176, v184
    v_mul_f32 v177, v177, v184
    v_cvt_pk_bf16_f32 v68, v176, v177
    v_mul_f32 v178, v178, v184
    v_mul_f32 v179, v179, v184
    v_mfma_f32_32x32x16_bf16 v[144:159], v[36:39], v[64:67], v[144:159]
    v_cvt_pk_bf16_f32 v69, v178, v179
    v_mul_f32 v180, v180, v184
    v_mul_f32 v181, v181, v184
    v_cvt_pk_bf16_f32 v70, v180, v181
    v_mul_f32 v182, v182, v184
    v_mul_f32 v183, v183, v184
    v_cvt_pk_bf16_f32 v71, v182, v183
    s_waitcnt lgkmcnt(0)
    v_mfma_f32_32x32x16_bf16 v[176:191], v[20:23], v[28:31], 0
    ds_read_b128 v[16:19], v10 offset:3264
    ds_read_b128 v[24:27], v11 offset:6144
    ds_read_b64_tr_b16 v[32:33], v8 offset:8192
    ds_read_b64_tr_b16 v[34:35], v8 offset:9216
    v_add_f32 v168, s48, v168
    v_rcp_f32 v168, v168
    v_mfma_f32_32x32x16_bf16 v[128:143], v[40:43], v[68:71], v[128:143]
    ds_read_b64_tr_b16 v[36:37], v9 offset:8192
    ds_read_b64_tr_b16 v[38:39], v9 offset:9216
    v_mul_f32 v160, v160, v168
    v_mul_f32 v161, v161, v168
    v_cvt_pk_bf16_f32 v64, v160, v161
    v_mul_f32 v162, v162, v168
    v_mul_f32 v163, v163, v168
    v_mfma_f32_32x32x16_bf16 v[144:159], v[44:47], v[68:71], v[144:159]
    v_cvt_pk_bf16_f32 v65, v162, v163
    v_mul_f32 v164, v164, v168
    v_mul_f32 v165, v165, v168
    v_cvt_pk_bf16_f32 v66, v164, v165
    v_mul_f32 v166, v166, v168
    v_mul_f32 v167, v167, v168
    v_cvt_pk_bf16_f32 v67, v166, v167
    s_waitcnt lgkmcnt(0)
    v_mfma_f32_32x32x16_bf16 v[160:175], v[16:19], v[24:27], 0
    ds_read_b128 v[20:23], v10 offset:3808
    ds_read_b128 v[28:31], v11 offset:7168
    ds_read_b64_tr_b16 v[40:41], v8 offset:10240
    ds_read_b64_tr_b16 v[42:43], v8 offset:11264
    v_add_f32 v184, s48, v184
    v_rcp_f32 v184, v184
    v_mfma_f32_32x32x16_bf16 v[128:143], v[32:35], v[64:67], v[128:143]
    ds_read_b64_tr_b16 v[44:45], v9 offset:10240
    ds_read_b64_tr_b16 v[46:47], v9 offset:11264
    v_mul_f32 v176, v176, v184
    v_mul_f32 v177, v177, v184
    v_cvt_pk_bf16_f32 v68, v176, v177
    v_mul_f32 v178, v178, v184
    v_mul_f32 v179, v179, v184
    v_mfma_f32_32x32x16_bf16 v[144:159], v[36:39], v[64:67], v[144:159]
    v_cvt_pk_bf16_f32 v69, v178, v179
    v_mul_f32 v180, v180, v184
    v_mul_f32 v181, v181, v184
    v_cvt_pk_bf16_f32 v70, v180, v181
    v_mul_f32 v182, v182, v184
    v_mul_f32 v183, v183, v184
    v_cvt_pk_bf16_f32 v71, v182, v183
    s_waitcnt lgkmcnt(0)
    v_mfma_f32_32x32x16_bf16 v[176:191], v[20:23], v[28:31], 0
    s_barrier
    ds_read_b128 v[16:19], v10 offset:4352
    ds_read_b128 v[24:27], v11 offset:8192
    ds_read_b64_tr_b16 v[32:33], v8 offset:12288
    ds_read_b64_tr_b16 v[34:35], v8 offset:13312
    v_add_f32 v168, s48, v168
    v_rcp_f32 v168, v168
    v_mfma_f32_32x32x16_bf16 v[128:143], v[40:43], v[68:71], v[128:143]
    ds_read_b64_tr_b16 v[36:37], v9 offset:12288
    ds_read_b64_tr_b16 v[38:39], v9 offset:13312
    v_mul_f32 v160, v160, v168
    v_mul_f32 v161, v161, v168
    v_cvt_pk_bf16_f32 v64, v160, v161
    v_mul_f32 v162, v162, v168
    v_mul_f32 v163, v163, v168
    v_mfma_f32_32x32x16_bf16 v[144:159], v[44:47], v[68:71], v[144:159]
    v_cvt_pk_bf16_f32 v65, v162, v163
    v_mul_f32 v164, v164, v168
    v_mul_f32 v165, v165, v168
    v_cvt_pk_bf16_f32 v66, v164, v165
    v_mul_f32 v166, v166, v168
    v_mul_f32 v167, v167, v168
    v_cvt_pk_bf16_f32 v67, v166, v167
    s_waitcnt lgkmcnt(0)
    v_mfma_f32_32x32x16_bf16 v[160:175], v[16:19], v[24:27], 0
    ds_read_b128 v[20:23], v10 offset:4896
    ds_read_b128 v[28:31], v11 offset:9216
    ds_read_b64_tr_b16 v[40:41], v8 offset:14336
    ds_read_b64_tr_b16 v[42:43], v8 offset:15360
    v_add_f32 v184, s48, v184
    v_rcp_f32 v184, v184
    v_mfma_f32_32x32x16_bf16 v[128:143], v[32:35], v[64:67], v[128:143]
    ds_read_b64_tr_b16 v[44:45], v9 offset:14336
    ds_read_b64_tr_b16 v[46:47], v9 offset:15360
    v_mul_f32 v176, v176, v184
    v_mul_f32 v177, v177, v184
    v_cvt_pk_bf16_f32 v68, v176, v177
    v_mul_f32 v178, v178, v184
    v_mul_f32 v179, v179, v184
    v_mfma_f32_32x32x16_bf16 v[144:159], v[36:39], v[64:67], v[144:159]
    v_cvt_pk_bf16_f32 v69, v178, v179
    v_mul_f32 v180, v180, v184
    v_mul_f32 v181, v181, v184
    v_cvt_pk_bf16_f32 v70, v180, v181
    v_mul_f32 v182, v182, v184
    v_mul_f32 v183, v183, v184
    v_cvt_pk_bf16_f32 v71, v182, v183
    s_waitcnt lgkmcnt(0)
    v_mfma_f32_32x32x16_bf16 v[176:191], v[20:23], v[28:31], 0
    ds_read_b128 v[16:19], v10 offset:5440
    ds_read_b128 v[24:27], v11 offset:10240
    ds_read_b64_tr_b16 v[32:33], v8 offset:16384
    ds_read_b64_tr_b16 v[34:35], v8 offset:17408
    v_add_f32 v168, s48, v168
    v_rcp_f32 v168, v168
    v_mfma_f32_32x32x16_bf16 v[128:143], v[40:43], v[68:71], v[128:143]
    ds_read_b64_tr_b16 v[36:37], v9 offset:16384
    ds_read_b64_tr_b16 v[38:39], v9 offset:17408
    v_mul_f32 v160, v160, v168
    v_mul_f32 v161, v161, v168
    v_cvt_pk_bf16_f32 v64, v160, v161
    v_mul_f32 v162, v162, v168
    v_mul_f32 v163, v163, v168
    v_mfma_f32_32x32x16_bf16 v[144:159], v[44:47], v[68:71], v[144:159]
    v_cvt_pk_bf16_f32 v65, v162, v163
    v_mul_f32 v164, v164, v168
    v_mul_f32 v165, v165, v168
    v_cvt_pk_bf16_f32 v66, v164, v165
    v_mul_f32 v166, v166, v168
    v_mul_f32 v167, v167, v168
    v_cvt_pk_bf16_f32 v67, v166, v167
    s_waitcnt lgkmcnt(0)
    v_mfma_f32_32x32x16_bf16 v[160:175], v[16:19], v[24:27], 0
    ds_read_b128 v[20:23], v10 offset:5984
    ds_read_b128 v[28:31], v11 offset:11264
    ds_read_b64_tr_b16 v[40:41], v8 offset:18432
    ds_read_b64_tr_b16 v[42:43], v8 offset:19456
    v_add_f32 v184, s48, v184
    v_rcp_f32 v184, v184
    v_mfma_f32_32x32x16_bf16 v[128:143], v[32:35], v[64:67], v[128:143]
    ds_read_b64_tr_b16 v[44:45], v9 offset:18432
    ds_read_b64_tr_b16 v[46:47], v9 offset:19456
    v_mul_f32 v176, v176, v184
    v_mul_f32 v177, v177, v184
    v_cvt_pk_bf16_f32 v68, v176, v177
    v_mul_f32 v178, v178, v184
    v_mul_f32 v179, v179, v184
    v_mfma_f32_32x32x16_bf16 v[144:159], v[36:39], v[64:67], v[144:159]
    v_cvt_pk_bf16_f32 v69, v178, v179
    v_mul_f32 v180, v180, v184
    v_mul_f32 v181, v181, v184
    v_cvt_pk_bf16_f32 v70, v180, v181
    v_mul_f32 v182, v182, v184
    v_mul_f32 v183, v183, v184
    v_cvt_pk_bf16_f32 v71, v182, v183
    s_waitcnt lgkmcnt(0)
    v_mfma_f32_32x32x16_bf16 v[176:191], v[20:23], v[28:31], 0
    s_barrier
    ds_read_b128 v[16:19], v10 offset:6528
    ds_read_b128 v[24:27], v11 offset:12288
    ds_read_b64_tr_b16 v[32:33], v8 offset:20480
    ds_read_b64_tr_b16 v[34:35], v8 offset:21504
    v_add_f32 v168, s48, v168
    v_rcp_f32 v168, v168
    v_mfma_f32_32x32x16_bf16 v[128:143], v[40:43], v[68:71], v[128:143]
    ds_read_b64_tr_b16 v[36:37], v9 offset:20480
    ds_read_b64_tr_b16 v[38:39], v9 offset:21504
    v_mul_f32 v160, v160, v168
    v_mul_f32 v161, v161, v168
    v_cvt_pk_bf16_f32 v64, v160, v161
    v_mul_f32 v162, v162, v168
    v_mul_f32 v163, v163, v168
    v_mfma_f32_32x32x16_bf16 v[144:159], v[44:47], v[68:71], v[144:159]
    v_cvt_pk_bf16_f32 v65, v162, v163
    v_mul_f32 v164, v164, v168
    v_mul_f32 v165, v165, v168
    v_cvt_pk_bf16_f32 v66, v164, v165
    v_mul_f32 v166, v166, v168
    v_mul_f32 v167, v167, v168
    v_cvt_pk_bf16_f32 v67, v166, v167
    s_waitcnt lgkmcnt(0)
    v_mfma_f32_32x32x16_bf16 v[160:175], v[16:19], v[24:27], 0
    ds_read_b128 v[20:23], v10 offset:7072
    ds_read_b128 v[28:31], v11 offset:13312
    ds_read_b64_tr_b16 v[40:41], v8 offset:22528
    ds_read_b64_tr_b16 v[42:43], v8 offset:23552
    v_add_f32 v184, s48, v184
    v_rcp_f32 v184, v184
    v_mfma_f32_32x32x16_bf16 v[128:143], v[32:35], v[64:67], v[128:143]
    ds_read_b64_tr_b16 v[44:45], v9 offset:22528
    ds_read_b64_tr_b16 v[46:47], v9 offset:23552
    v_mul_f32 v176, v176, v184
    v_mul_f32 v177, v177, v184
    v_cvt_pk_bf16_f32 v68, v176, v177
    v_mul_f32 v178, v178, v184
    v_mul_f32 v179, v179, v184
    v_mfma_f32_32x32x16_bf16 v[144:159], v[36:39], v[64:67], v[144:159]
    v_cvt_pk_bf16_f32 v69, v178, v179
    v_mul_f32 v180, v180, v184
    v_mul_f32 v181, v181, v184
    v_cvt_pk_bf16_f32 v70, v180, v181
    v_mul_f32 v182, v182, v184
    v_mul_f32 v183, v183, v184
    v_cvt_pk_bf16_f32 v71, v182, v183
    s_waitcnt lgkmcnt(0)
    v_mfma_f32_32x32x16_bf16 v[176:191], v[20:23], v[28:31], 0
    ds_read_b128 v[16:19], v10 offset:7616
    ds_read_b128 v[24:27], v11 offset:14336
    ds_read_b64_tr_b16 v[32:33], v8 offset:24576
    ds_read_b64_tr_b16 v[34:35], v8 offset:25600
    v_add_f32 v168, s48, v168
    v_rcp_f32 v168, v168
    v_mfma_f32_32x32x16_bf16 v[128:143], v[40:43], v[68:71], v[128:143]
    ds_read_b64_tr_b16 v[36:37], v9 offset:24576
    ds_read_b64_tr_b16 v[38:39], v9 offset:25600
    v_mul_f32 v160, v160, v168
    v_mul_f32 v161, v161, v168
    v_cvt_pk_bf16_f32 v64, v160, v161
    v_mul_f32 v162, v162, v168
    v_mul_f32 v163, v163, v168
    v_mfma_f32_32x32x16_bf16 v[144:159], v[44:47], v[68:71], v[144:159]
    v_cvt_pk_bf16_f32 v65, v162, v163
    v_mul_f32 v164, v164, v168
    v_mul_f32 v165, v165, v168
    v_cvt_pk_bf16_f32 v66, v164, v165
    v_mul_f32 v166, v166, v168
    v_mul_f32 v167, v167, v168
    v_cvt_pk_bf16_f32 v67, v166, v167
    s_waitcnt lgkmcnt(0)
    v_mfma_f32_32x32x16_bf16 v[160:175], v[16:19], v[24:27], 0
    ds_read_b128 v[20:23], v10 offset:8160
    ds_read_b128 v[28:31], v11 offset:15360
    ds_read_b64_tr_b16 v[40:41], v8 offset:26624
    ds_read_b64_tr_b16 v[42:43], v8 offset:27648
    v_add_f32 v184, s48, v184
    v_rcp_f32 v184, v184
    v_mfma_f32_32x32x16_bf16 v[128:143], v[32:35], v[64:67], v[128:143]
    ds_read_b64_tr_b16 v[44:45], v9 offset:26624
    ds_read_b64_tr_b16 v[46:47], v9 offset:27648
    v_mul_f32 v176, v176, v184
    v_mul_f32 v177, v177, v184
    v_cvt_pk_bf16_f32 v68, v176, v177
    v_mul_f32 v178, v178, v184
    v_mul_f32 v179, v179, v184
    v_mfma_f32_32x32x16_bf16 v[144:159], v[36:39], v[64:67], v[144:159]
    v_cvt_pk_bf16_f32 v69, v178, v179
    v_mul_f32 v180, v180, v184
    v_mul_f32 v181, v181, v184
    v_cvt_pk_bf16_f32 v70, v180, v181
    v_mul_f32 v182, v182, v184
    v_mul_f32 v183, v183, v184
    v_cvt_pk_bf16_f32 v71, v182, v183
    s_waitcnt lgkmcnt(0)
    v_mfma_f32_32x32x16_bf16 v[176:191], v[20:23], v[28:31], 0
    ds_read_b64_tr_b16 v[32:33], v8 offset:28672
    ds_read_b64_tr_b16 v[34:35], v8 offset:29696
    v_add_f32 v168, s48, v168
    v_rcp_f32 v168, v168
    v_mfma_f32_32x32x16_bf16 v[128:143], v[40:43], v[68:71], v[128:143]
    ds_read_b64_tr_b16 v[36:37], v9 offset:28672
    ds_read_b64_tr_b16 v[38:39], v9 offset:29696
    v_mul_f32 v160, v160, v168
    v_mul_f32 v161, v161, v168
    v_cvt_pk_bf16_f32 v64, v160, v161
    v_mul_f32 v162, v162, v168
    v_mul_f32 v163, v163, v168
    v_mfma_f32_32x32x16_bf16 v[144:159], v[44:47], v[68:71], v[144:159]
    v_cvt_pk_bf16_f32 v65, v162, v163
    v_mul_f32 v164, v164, v168
    v_mul_f32 v165, v165, v168
    v_cvt_pk_bf16_f32 v66, v164, v165
    v_mul_f32 v166, v166, v168
    v_mul_f32 v167, v167, v168
    v_cvt_pk_bf16_f32 v67, v166, v167
    s_waitcnt lgkmcnt(0)
    ds_read_b64_tr_b16 v[40:41], v8 offset:30720
    ds_read_b64_tr_b16 v[42:43], v8 offset:31744
    v_add_f32 v184, s48, v184
    v_rcp_f32 v184, v184
    v_mfma_f32_32x32x16_bf16 v[128:143], v[32:35], v[64:67], v[128:143]
    ds_read_b64_tr_b16 v[44:45], v9 offset:30720
    ds_read_b64_tr_b16 v[46:47], v9 offset:31744
    v_mul_f32 v176, v176, v184
    v_mul_f32 v177, v177, v184
    v_cvt_pk_bf16_f32 v68, v176, v177
    v_mul_f32 v178, v178, v184
    v_mul_f32 v179, v179, v184
    v_mfma_f32_32x32x16_bf16 v[144:159], v[36:39], v[64:67], v[144:159]
    v_cvt_pk_bf16_f32 v69, v178, v179
    v_mul_f32 v180, v180, v184
    v_mul_f32 v181, v181, v184
    v_cvt_pk_bf16_f32 v70, v180, v181
    v_mul_f32 v182, v182, v184
    v_mul_f32 v183, v183, v184
    v_cvt_pk_bf16_f32 v71, v182, v183
    s_waitcnt lgkmcnt(0)
    s_nop 0
    v_mfma_f32_32x32x16_bf16 v[128:143], v[40:43], v[68:71], v[128:143]
    v_mfma_f32_32x32x16_bf16 v[144:159], v[44:47], v[68:71], v[144:159]
    s_nop 11
    ds_write_b128 v11, v[144:147] offset:0
    ds_write_b128 v11, v[148:151] offset:1024
    ds_write_b128 v11, v[152:155] offset:2048
    ds_write_b128 v11, v[156:159] offset:3072
    s_waitcnt lgkmcnt(0)
    s_barrier
    ds_read_b128 v[160:163], v58 offset:0
    ds_read_b128 v[164:167], v58 offset:1024
    ds_read_b128 v[168:171], v58 offset:2048
    ds_read_b128 v[172:175], v58 offset:3072
    s_waitcnt lgkmcnt(3)
    v_pk_add_f32 v[128:129], v[128:129], v[160:161]
    v_cvt_pk_bf16_f32 v40, v128, v129
    ds_write_b16 v56, v40 offset:0
    ds_write_b16_d16_hi v56, v40 offset:144
    v_pk_mul_f32 v[50:51], v[128:129], v[128:129]
    v_pk_add_f32 v[130:131], v[130:131], v[162:163]
    v_cvt_pk_bf16_f32 v41, v130, v131
    ds_write_b16 v56, v41 offset:288
    ds_write_b16_d16_hi v56, v41 offset:432
    v_pk_fma_f32 v[50:51], v[130:131], v[130:131], v[50:51]
    v_pk_add_f32 v[128:129], v[130:131], v[128:129]
    s_waitcnt lgkmcnt(6)
    v_pk_add_f32 v[132:133], v[132:133], v[164:165]
    v_cvt_pk_bf16_f32 v42, v132, v133
    ds_write_b16 v56, v42 offset:1152
    ds_write_b16_d16_hi v56, v42 offset:1296
    v_pk_fma_f32 v[50:51], v[132:133], v[132:133], v[50:51]
    v_pk_add_f32 v[128:129], v[132:133], v[128:129]
    v_pk_add_f32 v[134:135], v[134:135], v[166:167]
    v_cvt_pk_bf16_f32 v43, v134, v135
    ds_write_b16 v56, v43 offset:1440
    ds_write_b16_d16_hi v56, v43 offset:1584
    v_pk_fma_f32 v[50:51], v[134:135], v[134:135], v[50:51]
    v_pk_add_f32 v[128:129], v[134:135], v[128:129]
    s_waitcnt lgkmcnt(9)
    v_pk_add_f32 v[136:137], v[136:137], v[168:169]
    v_cvt_pk_bf16_f32 v44, v136, v137
    ds_write_b16 v56, v44 offset:2304
    ds_write_b16_d16_hi v56, v44 offset:2448
    v_pk_fma_f32 v[50:51], v[136:137], v[136:137], v[50:51]
    v_pk_add_f32 v[128:129], v[136:137], v[128:129]
    v_pk_add_f32 v[138:139], v[138:139], v[170:171]
    v_cvt_pk_bf16_f32 v45, v138, v139
    ds_write_b16 v56, v45 offset:2592
    ds_write_b16_d16_hi v56, v45 offset:2736
    v_pk_fma_f32 v[50:51], v[138:139], v[138:139], v[50:51]
    v_pk_add_f32 v[128:129], v[138:139], v[128:129]
    s_waitcnt lgkmcnt(12)
    v_pk_add_f32 v[140:141], v[140:141], v[172:173]
    v_cvt_pk_bf16_f32 v46, v140, v141
    ds_write_b16 v56, v46 offset:3456
    ds_write_b16_d16_hi v56, v46 offset:3600
    v_pk_fma_f32 v[50:51], v[140:141], v[140:141], v[50:51]
    v_pk_add_f32 v[128:129], v[140:141], v[128:129]
    v_pk_add_f32 v[142:143], v[142:143], v[174:175]
    v_cvt_pk_bf16_f32 v47, v142, v143
    ds_write_b16 v56, v47 offset:3744
    ds_write_b16_d16_hi v56, v47 offset:3888
    v_pk_fma_f32 v[50:51], v[142:143], v[142:143], v[50:51]
    v_pk_add_f32 v[128:129], v[142:143], v[128:129]
    v_add_f32 v48, v128, v129
    v_add_f32 v50, v50, v51
    s_waitcnt lgkmcnt(0)
    s_barrier
    v_permlane32_swap_b32 v48, v50
    v_add_f32 v48, v48, v50
    buffer_atomic_add_f32 v48, v57, s[20:23], s50 offen
L_B_end:
    s_or_b32 s30, s2, s28
    s_or_b32 s30, s30, s68
    s_cmp_lg_u32 s30, 0
    s_cbranch_scc1 L_noep
    v_mov_b32 v2, s6
    v_mov_b32 v3, 0
    s_mov_b64 exec, 1
    buffer_store_dword v2, v3, s[20:23], s7 offen sc0 sc1
    s_mov_b64 exec, -1
L_noep:
    s_waitcnt vmcnt(0) lgkmcnt(0)
    s_barrier
    s_add_u32 s69, s69, 1
    s_cmp_lg_u32 s28, 7
    s_cbranch_scc1 L_arr0_B
    s_and_b32 s30, s2, 15
    s_lshl_b32 s30, s30, 8
    s_add_u32 s31, s30, 0xeb0000
    v_mov_b32 v2, 1
    v_mov_b32 v3, 0
    s_mov_b64 exec, 1
    buffer_atomic_add v2, v3, s[20:23], s31 offen sc0 sc1
    s_mov_b64 exec, -1
L_arr0_B:
    s_lshl_b32 s29, s36, 6
    s_lshl_b32 s33, s37, 1
    s_add_u32 s29, s29, s33
    v_lshlrev_b32 v5, 4, v1
    s_cmp_ge_u32 s28, 4
    s_cbranch_scc1 L_C_nsh
    s_lshr_b32 s40, s28, 1
    s_add_u32 s40, s40, s29
    s_mul_i32 s40, s40, 8448
    s_and_b32 s41, s28, 1
    s_lshl_b32 s41, s41, 2
    s_add_u32 s40, s40, s41
    s_add_u32 s40, s40, 0xa80000
    s_mul_i32 s41, s28, 8320
    s_add_u32 s41, s41, 9216
    s_mov_b32 m0, s41
    s_add_u32 s43, s40, 4224
    buffer_load_dwordx4 v5, s[20:23], s40 offen offset:0 sc1 lds
    buffer_load_dwordx4 v5, s[20:23], s40 offen offset:1024 sc1 lds
    buffer_load_dwordx4 v5, s[20:23], s40 offen offset:2048 sc1 lds
    buffer_load_dwordx4 v5, s[20:23], s40 offen offset:3072 sc1 lds
    s_add_u32 m0, s41, 4160
    v_mov_b32 v20, 0
    buffer_load_dwordx4 v5, s[20:23], s43 offen offset:0 sc1 lds
    buffer_load_dwordx4 v5, s[20:23], s43 offen offset:1024 sc1 lds
    buffer_load_dwordx4 v5, s[20:23], s43 offen offset:2048 sc1 lds
    buffer_load_dwordx4 v5, s[20:23], s43 offen offset:3072 sc1 lds
    v_lshlrev_b32 v21, 2, v1
    v_add_u32 v21, s41, v21
    s_mov_b64 exec, 0xffff
    ds_write_b32 v21, v20 offset:4096
    ds_write_b32 v21, v20 offset:8256
    s_mov_b64 exec, -1
L_C_nsh:
    v_lshlrev_b32 v30, 3, v0
    v_lshlrev_b32 v4, 4, v0
    s_lshl_b32 s50, s29, 12
    s_add_u32 s50, s50, s68
    s_add_u32 s50, s50, 0x200000
    s_add_u32 s51, s50, 4096
    s_add_u32 s52, s68, 0x409000
    s_add_u32 s53, s52, 8192
    s_lshl_b32 s42, s29, 1
    v_mov_b32 v20, 0
    v_and_b32 v21, 127, v0
    v_bfe_u32 v22, v0, 7, 1
    v_mul_u32_u24 v22, 4608, v22
    v_lshl_add_u32 v21, v21, 2, v22
    ds_write_b32 v21, v20 offset:0
    s_lshr_b32 s44, s28, 1
    s_and_b32 s44, s44, 1
    s_and_b32 s45, s28, 1
    v_and_b32 v22, 15, v1
    v_lshrrev_b32 v23, 4, v1
    v_sub_u32 v24, 3, v22
    v_and_b32 v24, 3, v24
    v_mul_u32_u24 v25, 4160, v24
    v_add_u32 v24, v24, v22
    v_sub_u32 v24, 15, v24
    v_lshl_add_u32 v24, v23, 3, v24
    v_lshl_add_u32 v24, v24, 1, v25
    s_mul_i32 s46, s44, 16640
    s_lshl_b32 s47, s45, 8
    s_sub_u32 s46, s46, s47
    s_add_u32 s46, s46, 9472
    v_add_u32 v6, s46, v24
    v_lshlrev_b32 v25, 5, v22
    v_lshl_add_u32 v25, v23, 4, v25
    s_mul_i32 s46, s44, 4608
    s_sub_u32 s46, s46, s47
    s_add_u32 s46, s46, 288
    v_add_u32 v7, s46, v25
    v_and_b32 v24, 3, v1
    v_lshlrev_b32 v24, 8, v24
    v_lshrrev_b32 v25, 2, v1
    v_lshl_add_u32 v24, v25, 4, v24
    s_lshl_b32 s46, s28, 10
    v_add_u32 v27, s46, v24
    v_mov_b32 v26, 0x3b000000
    s_lshl_b32 s48, s3, 16
    s_and_b32 s49, s3, 0xffff0000
    s_lshl_b32 s46, s28, 10
    s_add_u32 s46, s46, 131072
    v_add_u32 v25, s46, v5
    s_cmp_ge_u32 s28, 4
    s_cbranch_scc1 L_C_hb
    s_waitcnt vmcnt(0)
L_C_hb:
    s_waitcnt lgkmcnt(0)
    s_barrier
    s_cmp_lg_u32 s28, 7
    s_cbranch_scc1 L_arr_B
    s_lshl_b32 s31, s69, 4
    s_sub_u32 s31, s31, 1
    s_waitcnt vmcnt(0)
    v_readfirstlane_b32 s32, v2
    s_nop 0
    s_cmp_lg_u32 s32, s31
    s_cbranch_scc1 L_arr_B
    v_mov_b32 v2, 1
    v_lshlrev_b32 v3, 8, v1
    s_mov_b32 s30, 0xec0000
    buffer_atomic_add v2, v3, s[20:23], s30 offen sc1
    s_mov_b64 exec, -1
L_arr_B:
    s_cmp_ge_u32 s28, 4
    s_cbranch_scc1 L_C_noA
    ds_read_b64 v[128:129], v6 offset:3776
    ds_read_b64 v[130:131], v6 offset:3784
    ds_read_b64 v[132:133], v6 offset:3264
    ds_read_b64 v[134:135], v6 offset:3272
    ds_read_b64 v[136:137], v6 offset:2752
    ds_read_b64 v[138:139], v6 offset:2760
    ds_read_b64 v[140:141], v6 offset:2240
    ds_read_b64 v[142:143], v6 offset:2248
    ds_read_b64 v[144:145], v6 offset:1728
    ds_read_b64 v[146:147], v6 offset:1736
    ds_read_b64 v[148:149], v6 offset:1216
    ds_read_b64 v[150:151], v6 offset:1224
    ds_read_b64 v[152:153], v6 offset:704
    ds_read_b64 v[154:155], v6 offset:712
    ds_read_b64 v[156:157], v6 offset:192
    ds_read_b64 v[158:159], v6 offset:200
    ds_read_b64 v[160:161], v6 offset:3712
    ds_read_b64 v[162:163], v6 offset:3720
    ds_read_b64 v[164:165], v6 offset:3200
    ds_read_b64 v[166:167], v6 offset:3208
    ds_read_b64 v[168:169], v6 offset:2688
    ds_read_b64 v[170:171], v6 offset:2696
    ds_read_b64 v[172:173], v6 offset:2176
    ds_read_b64 v[174:175], v6 offset:2184
    ds_read_b64 v[176:177], v6 offset:1664
    ds_read_b64 v[178:179], v6 offset:1672
    ds_read_b64 v[180:181], v6 offset:1152
    ds_read_b64 v[182:183], v6 offset:1160
    ds_read_b64 v[184:185], v6 offset:640
    ds_read_b64 v[186:187], v6 offset:648
    ds_read_b64 v[188:189], v6 offset:128
    ds_read_b64 v[190:191], v6 offset:136
    ds_read_b64 v[192:193], v6 offset:3648
    ds_read_b64 v[194:195], v6 offset:3656
    ds_read_b64 v[196:197], v6 offset:3136
    ds_read_b64 v[198:199], v6 offset:3144
    ds_read_b64 v[200:201], v6 offset:2624
    ds_read_b64 v[202:203], v6 offset:2632
    ds_read_b64 v[204:205], v6 offset:2112
    ds_read_b64 v[206:207], v6 offset:2120
    ds_read_b64 v[208:209], v6 offset:1600
    ds_read_b64 v[210:211], v6 offset:1608
    ds_read_b64 v[212:213], v6 offset:1088
    ds_read_b64 v[214:215], v6 offset:1096
    ds_read_b64 v[216:217], v6 offset:576
    ds_read_b64 v[218:219], v6 offset:584
    ds_read_b64 v[220:221], v6 offset:64
    ds_read_b64 v[222:223], v6 offset:72
    ds_read_b64 v[224:225], v6 offset:3584
    ds_read_b64 v[226:227], v6 offset:3592
    ds_read_b64 v[228:229], v6 offset:3072
    ds_read_b64 v[230:231], v6 offset:3080
    ds_read_b64 v[232:233], v6 offset:2560
    ds_read_b64 v[234:235], v6 offset:2568
    ds_read_b64 v[236:237], v6 offset:2048
    ds_read_b64 v[238:239], v6 offset:2056
    ds_read_b64 v[240:241], v6 offset:1536
    ds_read_b64 v[242:243], v6 offset:1544
    ds_read_b64 v[244:245], v6 offset:1024
    ds_read_b64 v[246:247], v6 offset:1032
    ds_read_b64 v[248:249], v6 offset:512
    ds_read_b64 v[250:251], v6 offset:520
    ds_read_b64 v[252:253], v6 offset:0
    ds_read_b64 v[254:255], v6 offset:8
L_C_noA:
    s_cmp_lg_u32 s28, 6
    s_cbranch_scc1 L_gw_C
    s_and_b32 s30, s2, 63
    s_lshl_b32 s30, s30, 8
    s_add_u32 s30, s30, 0xec0000
    s_mov_b32 s31, 0
    s_lshl_b32 s32, s69, 4
    v_mov_b32 v3, 0
    v_mov_b32 v2, 0
    s_mov_b64 exec, 1
    buffer_atomic_add v2, v3, s[20:23], s30 offen sc0 sc1
L_gp_C:
    v_mov_b32 v31, 0
    s_sleep 1
    buffer_atomic_add v31, v3, s[20:23], s30 offen sc0 sc1
    s_add_u32 s31, s31, 1
    s_waitcnt vmcnt(1)
    v_cmp_gt_u32 vcc, s32, v2
    s_cbranch_vccz L_gd_C
    v_mov_b32 v2, 0
    s_sleep 1
    buffer_atomic_add v2, v3, s[20:23], s30 offen sc0 sc1
    s_cmp_gt_u32 s31, 200000
    s_cbranch_scc1 L_gd_C
    s_waitcnt vmcnt(1)
    v_cmp_gt_u32 vcc, s32, v31
    s_cbranch_vccnz L_gp_C
L_gd_C:
    s_mov_b64 exec, -1
L_gw_C:
    s_barrier
    buffer_load_dwordx4 v[8:11], v4, s[20:23], s52 offen sc1
    buffer_load_dwordx4 v[12:15], v4, s[20:23], s53 offen sc1
    buffer_load_dwordx2 v[16:17], v30, s[20:23], s50 offen sc1
    buffer_load_dwordx2 v[18:19], v30, s[20:23], s51 offen sc1
    s_waitcnt vmcnt(2)
    v_mul_f32 v8, 0xbb000000, v8
    v_mul_f32 v9, 0xbb000000, v9
    v_mul_f32 v10, 0xbb000000, v10
    v_mul_f32 v11, 0xbb000000, v11
    v_mul_f32 v44, v8, v8
    v_mul_f32 v45, v9, v9
    v_mul_f32 v46, v10, v10
    v_mul_f32 v47, v11, v11
    v_fma_f32 v12, v12, v26, -v44
    v_fma_f32 v13, v13, v26, -v45
    v_fma_f32 v14, v14, v26, -v46
    v_fma_f32 v15, v15, v26, -v47
    v_max_f32 v12, 0, v12
    v_max_f32 v13, 0, v13
    v_max_f32 v14, 0, v14
    v_max_f32 v15, 0, v15
    v_add_f32 v12, 0x3727c5ac, v12
    v_add_f32 v13, 0x3727c5ac, v13
    v_add_f32 v14, 0x3727c5ac, v14
    v_add_f32 v15, 0x3727c5ac, v15
    v_rsq_f32 v12, v12
    v_rsq_f32 v13, v13
    v_rsq_f32 v14, v14
    v_rsq_f32 v15, v15
    v_mul_f32 v8, v8, v12
    v_mul_f32 v9, v9, v13
    v_mul_f32 v10, v10, v14
    v_mul_f32 v11, v11, v15
    s_waitcnt vmcnt(1)
    v_lshlrev_b32 v36, 16, v16
    v_and_b32 v37, 0xffff0000, v16
    v_lshlrev_b32 v38, 16, v17
    v_and_b32 v39, 0xffff0000, v17
    v_fma_f32 v44, v36, v12, v8
    v_fma_f32 v45, v37, v13, v9
    v_fma_f32 v46, v38, v14, v10
    v_fma_f32 v47, v39, v15, v11
    v_cvt_pk_bf16_f32 v32, v44, v45
    v_cvt_pk_bf16_f32 v33, v46, v47
    ds_write_b64 v30, v[32:33] offset:512
    v_fmac_f32 v36, s48, v44
    v_fmac_f32 v37, s48, v45
    v_fmac_f32 v38, s48, v46
    v_fmac_f32 v39, s48, v47
    ds_write_b128 v27, v[36:39] offset:42496
    s_waitcnt vmcnt(0)
    v_lshlrev_b32 v40, 16, v18
    v_and_b32 v41, 0xffff0000, v18
    v_lshlrev_b32 v42, 16, v19
    v_and_b32 v43, 0xffff0000, v19
    v_fma_f32 v44, v40, v12, v8
    v_fma_f32 v45, v41, v13, v9
    v_fma_f32 v46, v42, v14, v10
    v_fma_f32 v47, v43, v15, v11
    v_cvt_pk_bf16_f32 v34, v44, v45
    v_cvt_pk_bf16_f32 v35, v46, v47
    ds_write_b64 v30, v[34:35] offset:5120
    v_fmac_f32 v40, s49, v44
    v_fmac_f32 v41, s49, v45
    v_fmac_f32 v42, s49, v46
    v_fmac_f32 v43, s49, v47
    ds_write_b128 v27, v[40:43] offset:50688
    s_waitcnt lgkmcnt(0)
    s_barrier
    s_cmp_ge_u32 s28, 4
    s_cbranch_scc1 L_C_help
    ds_read_b128 v[64:67], v7 offset:192
    ds_read_b128 v[68:71], v7 offset:704
    ds_read_b128 v[72:75], v7 offset:128
    ds_read_b128 v[76:79], v7 offset:640
    s_waitcnt lgkmcnt(3)
    v_mfma_f32_16x16x32_bf16 v[32:35], v[128:131], v[64:67], 0
    ds_read_b128 v[80:83], v7 offset:64
    v_mfma_f32_16x16x32_bf16 v[36:39], v[132:135], v[64:67], 0
    ds_read_b128 v[84:87], v7 offset:576
    s_waitcnt lgkmcnt(4)
    v_mfma_f32_16x16x32_bf16 v[36:39], v[128:131], v[68:71], v[36:39]
    ds_read_b128 v[88:91], v7 offset:0
    s_waitcnt lgkmcnt(4)
    v_mfma_f32_16x16x32_bf16 v[32:35], v[160:163], v[72:75], v[32:35]
    ds_read_b128 v[92:95], v7 offset:512
    v_mfma_f32_16x16x32_bf16 v[36:39], v[164:167], v[72:75], v[36:39]
    ds_read_b128 v[96:99], v7 offset:192
    s_waitcnt lgkmcnt(5)
    v_mfma_f32_16x16x32_bf16 v[36:39], v[160:163], v[76:79], v[36:39]
    ds_read_b128 v[100:103], v7 offset:704
    s_waitcnt lgkmcnt(5)
    v_mfma_f32_16x16x32_bf16 v[32:35], v[192:195], v[80:83], v[32:35]
    ds_read_b128 v[104:107], v7 offset:1216
    v_mfma_f32_16x16x32_bf16 v[36:39], v[196:199], v[80:83], v[36:39]
    ds_read_b128 v[108:111], v7 offset:1728
    s_waitcnt lgkmcnt(6)
    v_mfma_f32_16x16x32_bf16 v[36:39], v[192:195], v[84:87], v[36:39]
    ds_read_b128 v[112:115], v7 offset:128
    s_waitcnt lgkmcnt(6)
    v_mfma_f32_16x16x32_bf16 v[32:35], v[224:227], v[88:91], v[32:35]
    ds_read_b128 v[116:119], v7 offset:640
    v_mfma_f32_16x16x32_bf16 v[36:39], v[228:231], v[88:91], v[36:39]
    ds_read_b128 v[120:123], v7 offset:1152
    s_waitcnt lgkmcnt(7)
    v_mfma_f32_16x16x32_bf16 v[36:39], v[224:227], v[92:95], v[36:39]
    ds_read_b128 v[124:127], v7 offset:1664
    s_waitcnt lgkmcnt(7)
    v_mfma_f32_16x16x32_bf16 v[40:43], v[136:139], v[96:99], 0
    ds_read_b128 v[64:67], v7 offset:64
    v_mfma_f32_16x16x32_bf16 v[44:47], v[140:143], v[96:99], 0
    s_waitcnt lgkmcnt(7)
    v_mfma_f32_16x16x32_bf16 v[40:43], v[132:135], v[100:103], v[40:43]
    ds_read_b128 v[68:71], v7 offset:576
    v_mfma_f32_16x16x32_bf16 v[44:47], v[136:139], v[100:103], v[44:47]
    ds_write_b128 v25, v[32:35] offset:0
    ds_write_b128 v25, v[36:39] offset:4096
    s_waitcnt lgkmcnt(9)
    v_mfma_f32_16x16x32_bf16 v[40:43], v[128:131], v[104:107], v[40:43]
    ds_read_b128 v[72:75], v7 offset:1088
    v_mfma_f32_16x16x32_bf16 v[44:47], v[132:135], v[104:107], v[44:47]
    s_waitcnt lgkmcnt(9)
    v_mfma_f32_16x16x32_bf16 v[44:47], v[128:131], v[108:111], v[44:47]
    ds_read_b128 v[76:79], v7 offset:1600
    s_waitcnt lgkmcnt(9)
    v_mfma_f32_16x16x32_bf16 v[40:43], v[168:171], v[112:115], v[40:43]
    ds_read_b128 v[80:83], v7 offset:0
    v_mfma_f32_16x16x32_bf16 v[44:47], v[172:175], v[112:115], v[44:47]
    s_waitcnt lgkmcnt(9)
    v_mfma_f32_16x16x32_bf16 v[40:43], v[164:167], v[116:119], v[40:43]
    s_waitcnt lgkmcnt(3)
    s_barrier
    ds_read_b128 v[84:87], v7 offset:512
    v_mfma_f32_16x16x32_bf16 v[44:47], v[168:171], v[116:119], v[44:47]
    v_mfma_f32_16x16x32_bf16 v[40:43], v[160:163], v[120:123], v[40:43]
    ds_read_b128 v[88:91], v7 offset:1024
    v_mfma_f32_16x16x32_bf16 v[44:47], v[164:167], v[120:123], v[44:47]
    v_mfma_f32_16x16x32_bf16 v[44:47], v[160:163], v[124:127], v[44:47]
    ds_read_b128 v[92:95], v7 offset:1536
    v_mfma_f32_16x16x32_bf16 v[40:43], v[200:203], v[64:67], v[40:43]
    ds_read_b128 v[96:99], v7 offset:192
    v_mfma_f32_16x16x32_bf16 v[44:47], v[204:207], v[64:67], v[44:47]
    v_mfma_f32_16x16x32_bf16 v[40:43], v[196:199], v[68:71], v[40:43]
    ds_read_b128 v[100:103], v7 offset:704
    v_mfma_f32_16x16x32_bf16 v[44:47], v[200:203], v[68:71], v[44:47]
    s_waitcnt lgkmcnt(7)
    v_mfma_f32_16x16x32_bf16 v[40:43], v[192:195], v[72:75], v[40:43]
    ds_read_b128 v[104:107], v7 offset:1216
    v_mfma_f32_16x16x32_bf16 v[44:47], v[196:199], v[72:75], v[44:47]
    s_waitcnt lgkmcnt(7)
    v_mfma_f32_16x16x32_bf16 v[44:47], v[192:195], v[76:79], v[44:47]
    ds_read_b128 v[108:111], v7 offset:1728
    s_waitcnt lgkmcnt(7)
    v_mfma_f32_16x16x32_bf16 v[40:43], v[232:235], v[80:83], v[40:43]
    v_mfma_f32_16x16x32_bf16 v[44:47], v[236:239], v[80:83], v[44:47]
    ds_read_b128 v[112:115], v7 offset:2240
    s_waitcnt lgkmcnt(7)
    v_mfma_f32_16x16x32_bf16 v[40:43], v[228:231], v[84:87], v[40:43]
    v_mfma_f32_16x16x32_bf16 v[44:47], v[232:235], v[84:87], v[44:47]
    ds_read_b128 v[116:119], v7 offset:2752
    s_waitcnt lgkmcnt(7)
    v_mfma_f32_16x16x32_bf16 v[40:43], v[224:227], v[88:91], v[40:43]
    ds_read_b128 v[120:123], v7 offset:128
    v_mfma_f32_16x16x32_bf16 v[44:47], v[228:231], v[88:91], v[44:47]
    s_waitcnt lgkmcnt(7)
    v_mfma_f32_16x16x32_bf16 v[44:47], v[224:227], v[92:95], v[44:47]
    ds_read_b128 v[124:127], v7 offset:640
    s_waitcnt lgkmcnt(7)
    v_mfma_f32_16x16x32_bf16 v[48:51], v[144:147], v[96:99], 0
    v_mfma_f32_16x16x32_bf16 v[52:55], v[148:151], v[96:99], 0
    ds_read_b128 v[64:67], v7 offset:1152
    s_waitcnt lgkmcnt(7)
    v_mfma_f32_16x16x32_bf16 v[48:51], v[140:143], v[100:103], v[48:51]
    v_mfma_f32_16x16x32_bf16 v[52:55], v[144:147], v[100:103], v[52:55]
    ds_write_b128 v25, v[40:43] offset:8192
    ds_write_b128 v25, v[44:47] offset:12288
    ds_read_b128 v[68:71], v7 offset:1664
    s_waitcnt lgkmcnt(9)
    v_mfma_f32_16x16x32_bf16 v[48:51], v[136:139], v[104:107], v[48:51]
    v_mfma_f32_16x16x32_bf16 v[52:55], v[140:143], v[104:107], v[52:55]
    ds_read_b128 v[72:75], v7 offset:2176
    s_waitcnt lgkmcnt(9)
    v_mfma_f32_16x16x32_bf16 v[48:51], v[132:135], v[108:111], v[48:51]
    v_mfma_f32_16x16x32_bf16 v[52:55], v[136:139], v[108:111], v[52:55]
    ds_read_b128 v[76:79], v7 offset:2688
    s_waitcnt lgkmcnt(9)
    v_mfma_f32_16x16x32_bf16 v[48:51], v[128:131], v[112:115], v[48:51]
    ds_read_b128 v[80:83], v7 offset:64
    v_mfma_f32_16x16x32_bf16 v[52:55], v[132:135], v[112:115], v[52:55]
    s_waitcnt lgkmcnt(4)
    s_barrier
    v_mfma_f32_16x16x32_bf16 v[52:55], v[128:131], v[116:119], v[52:55]
    ds_read_b128 v[84:87], v7 offset:576
    v_mfma_f32_16x16x32_bf16 v[48:51], v[176:179], v[120:123], v[48:51]
    v_mfma_f32_16x16x32_bf16 v[52:55], v[180:183], v[120:123], v[52:55]
    ds_read_b128 v[88:91], v7 offset:1088
    v_mfma_f32_16x16x32_bf16 v[48:51], v[172:175], v[124:127], v[48:51]
    v_mfma_f32_16x16x32_bf16 v[52:55], v[176:179], v[124:127], v[52:55]
    ds_read_b128 v[92:95], v7 offset:1600
    v_mfma_f32_16x16x32_bf16 v[48:51], v[168:171], v[64:67], v[48:51]
    v_mfma_f32_16x16x32_bf16 v[52:55], v[172:175], v[64:67], v[52:55]
    ds_read_b128 v[96:99], v7 offset:2112
    s_waitcnt lgkmcnt(7)
    v_mfma_f32_16x16x32_bf16 v[48:51], v[164:167], v[68:71], v[48:51]
    v_mfma_f32_16x16x32_bf16 v[52:55], v[168:171], v[68:71], v[52:55]
    ds_read_b128 v[100:103], v7 offset:2624
    s_waitcnt lgkmcnt(7)
    v_mfma_f32_16x16x32_bf16 v[48:51], v[160:163], v[72:75], v[48:51]
    ds_read_b128 v[104:107], v7 offset:0
    v_mfma_f32_16x16x32_bf16 v[52:55], v[164:167], v[72:75], v[52:55]
    s_waitcnt lgkmcnt(7)
    v_mfma_f32_16x16x32_bf16 v[52:55], v[160:163], v[76:79], v[52:55]
    ds_read_b128 v[108:111], v7 offset:512
    s_waitcnt lgkmcnt(7)
    v_mfma_f32_16x16x32_bf16 v[48:51], v[208:211], v[80:83], v[48:51]
    v_mfma_f32_16x16x32_bf16 v[52:55], v[212:215], v[80:83], v[52:55]
    ds_read_b128 v[112:115], v7 offset:1024
    s_waitcnt lgkmcnt(7)
    v_mfma_f32_16x16x32_bf16 v[48:51], v[204:207], v[84:87], v[48:51]
    v_mfma_f32_16x16x32_bf16 v[52:55], v[208:211], v[84:87], v[52:55]
    ds_read_b128 v[116:119], v7 offset:1536
    s_waitcnt lgkmcnt(7)
    v_mfma_f32_16x16x32_bf16 v[48:51], v[200:203], v[88:91], v[48:51]
    v_mfma_f32_16x16x32_bf16 v[52:55], v[204:207], v[88:91], v[52:55]
    ds_read_b128 v[120:123], v7 offset:2048
    s_waitcnt lgkmcnt(7)
    v_mfma_f32_16x16x32_bf16 v[48:51], v[196:199], v[92:95], v[48:51]
    v_mfma_f32_16x16x32_bf16 v[52:55], v[200:203], v[92:95], v[52:55]
    ds_read_b128 v[124:127], v7 offset:2560
    s_waitcnt lgkmcnt(7)
    v_mfma_f32_16x16x32_bf16 v[48:51], v[192:195], v[96:99], v[48:51]
    ds_read_b128 v[64:67], v7 offset:192
    v_mfma_f32_16x16x32_bf16 v[52:55], v[196:199], v[96:99], v[52:55]
    s_waitcnt lgkmcnt(7)
    v_mfma_f32_16x16x32_bf16 v[52:55], v[192:195], v[100:103], v[52:55]
    ds_read_b128 v[68:71], v7 offset:704
    s_waitcnt lgkmcnt(7)
    v_mfma_f32_16x16x32_bf16 v[48:51], v[240:243], v[104:107], v[48:51]
    v_mfma_f32_16x16x32_bf16 v[52:55], v[244:247], v[104:107], v[52:55]
    ds_read_b128 v[72:75], v7 offset:1216
    s_waitcnt lgkmcnt(7)
    v_mfma_f32_16x16x32_bf16 v[48:51], v[236:239], v[108:111], v[48:51]
    v_mfma_f32_16x16x32_bf16 v[52:55], v[240:243], v[108:111], v[52:55]
    ds_read_b128 v[76:79], v7 offset:1728
    s_waitcnt lgkmcnt(7)
    v_mfma_f32_16x16x32_bf16 v[48:51], v[232:235], v[112:115], v[48:51]
    v_mfma_f32_16x16x32_bf16 v[52:55], v[236:239], v[112:115], v[52:55]
    ds_read_b128 v[80:83], v7 offset:2240
    s_waitcnt lgkmcnt(7)
    v_mfma_f32_16x16x32_bf16 v[48:51], v[228:231], v[116:119], v[48:51]
    v_mfma_f32_16x16x32_bf16 v[52:55], v[232:235], v[116:119], v[52:55]
    ds_read_b128 v[84:87], v7 offset:2752
    s_waitcnt lgkmcnt(7)
    v_mfma_f32_16x16x32_bf16 v[48:51], v[224:227], v[120:123], v[48:51]
    v_mfma_f32_16x16x32_bf16 v[52:55], v[228:231], v[120:123], v[52:55]
    ds_read_b128 v[88:91], v7 offset:3264
    s_waitcnt lgkmcnt(7)
    v_mfma_f32_16x16x32_bf16 v[52:55], v[224:227], v[124:127], v[52:55]
    s_waitcnt lgkmcnt(6)
    v_mfma_f32_16x16x32_bf16 v[56:59], v[152:155], v[64:67], 0
    ds_read_b128 v[92:95], v7 offset:3776
    v_mfma_f32_16x16x32_bf16 v[60:63], v[156:159], v[64:67], 0
    ds_read_b128 v[96:99], v7 offset:128
    s_waitcnt lgkmcnt(7)
    v_mfma_f32_16x16x32_bf16 v[56:59], v[148:151], v[68:71], v[56:59]
    v_mfma_f32_16x16x32_bf16 v[60:63], v[152:155], v[68:71], v[60:63]
    ds_write_b128 v25, v[48:51] offset:16384
    ds_write_b128 v25, v[52:55] offset:20480
    ds_read_b128 v[100:103], v7 offset:640
    s_waitcnt lgkmcnt(9)
    v_mfma_f32_16x16x32_bf16 v[56:59], v[144:147], v[72:75], v[56:59]
    v_mfma_f32_16x16x32_bf16 v[60:63], v[148:151], v[72:75], v[60:63]
    ds_read_b128 v[104:107], v7 offset:1152
    s_waitcnt lgkmcnt(9)
    v_mfma_f32_16x16x32_bf16 v[56:59], v[140:143], v[76:79], v[56:59]
    v_mfma_f32_16x16x32_bf16 v[60:63], v[144:147], v[76:79], v[60:63]
    ds_read_b128 v[108:111], v7 offset:1664
    s_waitcnt lgkmcnt(9)
    v_mfma_f32_16x16x32_bf16 v[56:59], v[136:139], v[80:83], v[56:59]
    v_mfma_f32_16x16x32_bf16 v[60:63], v[140:143], v[80:83], v[60:63]
    s_waitcnt lgkmcnt(3)
    s_barrier
    ds_read_b128 v[112:115], v7 offset:2176
    v_mfma_f32_16x16x32_bf16 v[56:59], v[132:135], v[84:87], v[56:59]
    v_mfma_f32_16x16x32_bf16 v[60:63], v[136:139], v[84:87], v[60:63]
    ds_read_b128 v[116:119], v7 offset:2688
    v_mfma_f32_16x16x32_bf16 v[56:59], v[128:131], v[88:91], v[56:59]
    v_mfma_f32_16x16x32_bf16 v[60:63], v[132:135], v[88:91], v[60:63]
    ds_read_b128 v[120:123], v7 offset:3200
    v_mfma_f32_16x16x32_bf16 v[60:63], v[128:131], v[92:95], v[60:63]
    v_mfma_f32_16x16x32_bf16 v[56:59], v[184:187], v[96:99], v[56:59]
    ds_read_b128 v[124:127], v7 offset:3712
    v_mfma_f32_16x16x32_bf16 v[60:63], v[188:191], v[96:99], v[60:63]
    ds_read_b128 v[64:67], v7 offset:64
    s_waitcnt lgkmcnt(7)
    v_mfma_f32_16x16x32_bf16 v[56:59], v[180:183], v[100:103], v[56:59]
    v_mfma_f32_16x16x32_bf16 v[60:63], v[184:187], v[100:103], v[60:63]
    ds_read_b128 v[68:71], v7 offset:576
    s_waitcnt lgkmcnt(7)
    v_mfma_f32_16x16x32_bf16 v[56:59], v[176:179], v[104:107], v[56:59]
    v_mfma_f32_16x16x32_bf16 v[60:63], v[180:183], v[104:107], v[60:63]
    ds_read_b128 v[72:75], v7 offset:1088
    s_waitcnt lgkmcnt(7)
    v_mfma_f32_16x16x32_bf16 v[56:59], v[172:175], v[108:111], v[56:59]
    v_mfma_f32_16x16x32_bf16 v[60:63], v[176:179], v[108:111], v[60:63]
    ds_read_b128 v[76:79], v7 offset:1600
    s_waitcnt lgkmcnt(7)
    v_mfma_f32_16x16x32_bf16 v[56:59], v[168:171], v[112:115], v[56:59]
    v_mfma_f32_16x16x32_bf16 v[60:63], v[172:175], v[112:115], v[60:63]
    ds_read_b128 v[80:83], v7 offset:2112
    s_waitcnt lgkmcnt(7)
    v_mfma_f32_16x16x32_bf16 v[56:59], v[164:167], v[116:119], v[56:59]
    v_mfma_f32_16x16x32_bf16 v[60:63], v[168:171], v[116:119], v[60:63]
    ds_read_b128 v[84:87], v7 offset:2624
    s_waitcnt lgkmcnt(7)
    v_mfma_f32_16x16x32_bf16 v[56:59], v[160:163], v[120:123], v[56:59]
    v_mfma_f32_16x16x32_bf16 v[60:63], v[164:167], v[120:123], v[60:63]
    ds_read_b128 v[88:91], v7 offset:3136
    s_waitcnt lgkmcnt(7)
    v_mfma_f32_16x16x32_bf16 v[60:63], v[160:163], v[124:127], v[60:63]
    s_waitcnt lgkmcnt(6)
    v_mfma_f32_16x16x32_bf16 v[56:59], v[216:219], v[64:67], v[56:59]
    ds_read_b128 v[92:95], v7 offset:3648
    v_mfma_f32_16x16x32_bf16 v[60:63], v[220:223], v[64:67], v[60:63]
    ds_read_b128 v[96:99], v7 offset:0
    s_waitcnt lgkmcnt(7)
    v_mfma_f32_16x16x32_bf16 v[56:59], v[212:215], v[68:71], v[56:59]
    v_mfma_f32_16x16x32_bf16 v[60:63], v[216:219], v[68:71], v[60:63]
    ds_read_b128 v[100:103], v7 offset:512
    s_waitcnt lgkmcnt(7)
    v_mfma_f32_16x16x32_bf16 v[56:59], v[208:211], v[72:75], v[56:59]
    v_mfma_f32_16x16x32_bf16 v[60:63], v[212:215], v[72:75], v[60:63]
    ds_read_b128 v[104:107], v7 offset:1024
    s_waitcnt lgkmcnt(7)
    v_mfma_f32_16x16x32_bf16 v[56:59], v[204:207], v[76:79], v[56:59]
    v_mfma_f32_16x16x32_bf16 v[60:63], v[208:211], v[76:79], v[60:63]
    ds_read_b128 v[108:111], v7 offset:1536
    s_waitcnt lgkmcnt(7)
    v_mfma_f32_16x16x32_bf16 v[56:59], v[200:203], v[80:83], v[56:59]
    v_mfma_f32_16x16x32_bf16 v[60:63], v[204:207], v[80:83], v[60:63]
    ds_read_b128 v[112:115], v7 offset:2048
    s_waitcnt lgkmcnt(7)
    v_mfma_f32_16x16x32_bf16 v[56:59], v[196:199], v[84:87], v[56:59]
    v_mfma_f32_16x16x32_bf16 v[60:63], v[200:203], v[84:87], v[60:63]
    ds_read_b128 v[116:119], v7 offset:2560
    s_waitcnt lgkmcnt(7)
    v_mfma_f32_16x16x32_bf16 v[56:59], v[192:195], v[88:91], v[56:59]
    v_mfma_f32_16x16x32_bf16 v[60:63], v[196:199], v[88:91], v[60:63]
    ds_read_b128 v[120:123], v7 offset:3072
    s_waitcnt lgkmcnt(7)
    v_mfma_f32_16x16x32_bf16 v[60:63], v[192:195], v[92:95], v[60:63]
    s_waitcnt lgkmcnt(6)
    v_mfma_f32_16x16x32_bf16 v[56:59], v[248:251], v[96:99], v[56:59]
    ds_read_b128 v[124:127], v7 offset:3584
    v_mfma_f32_16x16x32_bf16 v[60:63], v[252:255], v[96:99], v[60:63]
    s_waitcnt lgkmcnt(6)
    v_mfma_f32_16x16x32_bf16 v[56:59], v[244:247], v[100:103], v[56:59]
    v_mfma_f32_16x16x32_bf16 v[60:63], v[248:251], v[100:103], v[60:63]
    s_waitcnt lgkmcnt(5)
    v_mfma_f32_16x16x32_bf16 v[56:59], v[240:243], v[104:107], v[56:59]
    v_mfma_f32_16x16x32_bf16 v[60:63], v[244:247], v[104:107], v[60:63]
    s_waitcnt lgkmcnt(4)
    v_mfma_f32_16x16x32_bf16 v[56:59], v[236:239], v[108:111], v[56:59]
    v_mfma_f32_16x16x32_bf16 v[60:63], v[240:243], v[108:111], v[60:63]
    s_waitcnt lgkmcnt(3)
    v_mfma_f32_16x16x32_bf16 v[56:59], v[232:235], v[112:115], v[56:59]
    v_mfma_f32_16x16x32_bf16 v[60:63], v[236:239], v[112:115], v[60:63]
    s_waitcnt lgkmcnt(2)
    v_mfma_f32_16x16x32_bf16 v[56:59], v[228:231], v[116:119], v[56:59]
    v_mfma_f32_16x16x32_bf16 v[60:63], v[232:235], v[116:119], v[60:63]
    s_waitcnt lgkmcnt(1)
    v_mfma_f32_16x16x32_bf16 v[56:59], v[224:227], v[120:123], v[56:59]
    v_mfma_f32_16x16x32_bf16 v[60:63], v[228:231], v[120:123], v[60:63]
    s_waitcnt lgkmcnt(0)
    v_mfma_f32_16x16x32_bf16 v[60:63], v[224:227], v[124:127], v[60:63]
    s_nop 4
    ds_write_b128 v25, v[56:59] offset:24576
    s_nop 1
    ds_write_b128 v25, v[60:63] offset:28672
    s_waitcnt lgkmcnt(0)
    s_barrier
    s_branch L_C_fin
L_C_help:
    s_sub_u32 s46, s28, 4
    s_cmp_lg_u32 s68, 0
    s_cbranch_scc1 L_C_help1
    v_lshrrev_b32 v20, 5, v1
    v_bfe_u32 v21, v1, 1, 4
    v_and_b32 v22, 1, v1
    v_lshlrev_b32 v23, 9, v22
    v_lshl_add_u32 v23, v21, 4, v23
    v_lshl_add_u32 v24, v20, 11, v23
    s_lshl_b32 s47, s46, 12
    s_add_u32 s47, s47, 131072
    v_add_u32 v24, s47, v24
    v_lshl_add_u32 v26, v20, 13, v23
    s_lshl_b32 s47, s46, 10
    s_add_u32 s47, s47, 42496
    v_add_u32 v26, s47, v26
    v_and_b32 v25, 31, v1
    v_lshlrev_b32 v25, 4, v25
    v_lshl_add_u32 v25, v20, 12, v25
    s_lshl_b32 s47, s29, 12
    s_lshl_b32 s43, s46, 9
    s_add_u32 s47, s47, s43
    s_add_u32 s47, s47, 0x880000
    s_lshr_b32 s43, s46, 1
    ds_read_b128 v[56:59], v26 offset:0
    ds_read_b128 v[60:63], v26 offset:256
    ds_read_b128 v[64:67], v26 offset:4096
    ds_read_b128 v[68:71], v26 offset:4352
    s_barrier
    s_cmp_lg_u32 s43, 0
    s_cbranch_scc1 L_C_h0_0
    ds_read_b128 v[32:35], v24 offset:0
    ds_read_b128 v[36:39], v24 offset:1024
    ds_read_b128 v[40:43], v24 offset:256
    ds_read_b128 v[44:47], v24 offset:1280
    s_waitcnt lgkmcnt(2)
    v_add_f32 v32, v32, v56
    v_add_f32 v33, v33, v57
    v_add_f32 v34, v34, v58
    v_add_f32 v35, v35, v59
    v_add_f32 v32, v32, v36
    v_add_f32 v33, v33, v37
    v_add_f32 v34, v34, v38
    v_add_f32 v35, v35, v39
    v_cvt_pk_bf16_f32 v48, v32, v33
    v_cvt_pk_bf16_f32 v49, v34, v35
    s_waitcnt lgkmcnt(0)
    v_add_f32 v40, v40, v60
    v_add_f32 v41, v41, v61
    v_add_f32 v42, v42, v62
    v_add_f32 v43, v43, v63
    v_add_f32 v40, v40, v44
    v_add_f32 v41, v41, v45
    v_add_f32 v42, v42, v46
    v_add_f32 v43, v43, v47
    v_cvt_pk_bf16_f32 v50, v40, v41
    v_cvt_pk_bf16_f32 v51, v42, v43
    buffer_store_dwordx4 v[48:51], v25, s[20:23], s47 offen offset:0 sc1
L_C_h0_0:
    s_barrier
    s_cmp_lg_u32 s43, 1
    s_cbranch_scc1 L_C_h0_1
    ds_read_b128 v[32:35], v24 offset:0
    ds_read_b128 v[36:39], v24 offset:1024
    ds_read_b128 v[40:43], v24 offset:256
    ds_read_b128 v[44:47], v24 offset:1280
    s_waitcnt lgkmcnt(2)
    v_add_f32 v32, v32, v56
    v_add_f32 v33, v33, v57
    v_add_f32 v34, v34, v58
    v_add_f32 v35, v35, v59
    v_add_f32 v32, v32, v36
    v_add_f32 v33, v33, v37
    v_add_f32 v34, v34, v38
    v_add_f32 v35, v35, v39
    v_cvt_pk_bf16_f32 v48, v32, v33
    v_cvt_pk_bf16_f32 v49, v34, v35
    s_waitcnt lgkmcnt(0)
    v_add_f32 v40, v40, v60
    v_add_f32 v41, v41, v61
    v_add_f32 v42, v42, v62
    v_add_f32 v43, v43, v63
    v_add_f32 v40, v40, v44
    v_add_f32 v41, v41, v45
    v_add_f32 v42, v42, v46
    v_add_f32 v43, v43, v47
    v_cvt_pk_bf16_f32 v50, v40, v41
    v_cvt_pk_bf16_f32 v51, v42, v43
    buffer_store_dwordx4 v[48:51], v25, s[20:23], s47 offen offset:0 sc1
L_C_h0_1:
    s_barrier
    s_cmp_lg_u32 s43, 0
    s_cbranch_scc1 L_C_h0_2
    ds_read_b128 v[32:35], v24 offset:16384
    ds_read_b128 v[36:39], v24 offset:17408
    ds_read_b128 v[40:43], v24 offset:16640
    ds_read_b128 v[44:47], v24 offset:17664
    s_waitcnt lgkmcnt(2)
    v_add_f32 v32, v32, v64
    v_add_f32 v33, v33, v65
    v_add_f32 v34, v34, v66
    v_add_f32 v35, v35, v67
    v_add_f32 v32, v32, v36
    v_add_f32 v33, v33, v37
    v_add_f32 v34, v34, v38
    v_add_f32 v35, v35, v39
    v_cvt_pk_bf16_f32 v52, v32, v33
    v_cvt_pk_bf16_f32 v53, v34, v35
    s_waitcnt lgkmcnt(0)
    v_add_f32 v40, v40, v68
    v_add_f32 v41, v41, v69
    v_add_f32 v42, v42, v70
    v_add_f32 v43, v43, v71
    v_add_f32 v40, v40, v44
    v_add_f32 v41, v41, v45
    v_add_f32 v42, v42, v46
    v_add_f32 v43, v43, v47
    v_cvt_pk_bf16_f32 v54, v40, v41
    v_cvt_pk_bf16_f32 v55, v42, v43
    buffer_store_dwordx4 v[52:55], v25, s[20:23], s47 offen offset:2048 sc1
L_C_h0_2:
    s_barrier
    s_cmp_lg_u32 s43, 1
    s_cbranch_scc1 L_C_h0_3
    ds_read_b128 v[32:35], v24 offset:16384
    ds_read_b128 v[36:39], v24 offset:17408
    ds_read_b128 v[40:43], v24 offset:16640
    ds_read_b128 v[44:47], v24 offset:17664
    s_waitcnt lgkmcnt(2)
    v_add_f32 v32, v32, v64
    v_add_f32 v33, v33, v65
    v_add_f32 v34, v34, v66
    v_add_f32 v35, v35, v67
    v_add_f32 v32, v32, v36
    v_add_f32 v33, v33, v37
    v_add_f32 v34, v34, v38
    v_add_f32 v35, v35, v39
    v_cvt_pk_bf16_f32 v52, v32, v33
    v_cvt_pk_bf16_f32 v53, v34, v35
    s_waitcnt lgkmcnt(0)
    v_add_f32 v40, v40, v68
    v_add_f32 v41, v41, v69
    v_add_f32 v42, v42, v70
    v_add_f32 v43, v43, v71
    v_add_f32 v40, v40, v44
    v_add_f32 v41, v41, v45
    v_add_f32 v42, v42, v46
    v_add_f32 v43, v43, v47
    v_cvt_pk_bf16_f32 v54, v40, v41
    v_cvt_pk_bf16_f32 v55, v42, v43
    buffer_store_dwordx4 v[52:55], v25, s[20:23], s47 offen offset:2048 sc1
L_C_h0_3:
    s_branch L_C_fin
L_C_help1:
    s_lshr_b32 s43, s46, 1
    s_and_b32 s46, s46, 1
    s_lshl_b32 s47, s43, 12
    s_lshl_b32 s40, s46, 3
    s_add_u32 s47, s47, s40
    s_add_u32 s47, s47, 131072
    v_add_u32 v24, s47, v5
    s_lshl_b32 s47, s43, 10
    s_add_u32 s47, s47, s40
    s_add_u32 s47, s47, 42496
    v_add_u32 v26, s47, v5
    v_lshlrev_b32 v25, 4, v22
    v_lshl_add_u32 v25, v23, 2, v25
    v_lshlrev_b32 v25, 10, v25
    s_lshl_b32 s47, s43, 18
    s_lshl_b32 s40, s46, 11
    s_add_u32 s47, s47, s40
    s_add_u32 s47, s47, s42
    ds_read_b64 v[56:57], v26 offset:0
    ds_read_b64 v[58:59], v26 offset:8192
    ds_read_b64 v[60:61], v26 offset:2048
    ds_read_b64 v[62:63], v26 offset:10240
    ds_read_b64 v[64:65], v26 offset:4096
    ds_read_b64 v[66:67], v26 offset:12288
    ds_read_b64 v[68:69], v26 offset:6144
    ds_read_b64 v[70:71], v26 offset:14336
    s_barrier
    ds_read_b64 v[32:33], v24 offset:0
    ds_read_b64 v[34:35], v24 offset:1024
    ds_read_b64 v[36:37], v24 offset:2048
    ds_read_b64 v[38:39], v24 offset:3072
    s_waitcnt lgkmcnt(2)
    v_add_f32 v32, v32, v56
    v_add_f32 v33, v33, v57
    v_add_f32 v32, v32, v34
    v_add_f32 v33, v33, v35
    s_waitcnt lgkmcnt(0)
    v_add_f32 v36, v36, v58
    v_add_f32 v37, v37, v59
    v_add_f32 v36, v36, v38
    v_add_f32 v37, v37, v39
    v_cvt_pk_bf16_f32 v48, v32, v36
    buffer_store_dword v48, v25, s[64:67], s47 offen offset:0
    v_cvt_pk_bf16_f32 v49, v33, v37
    buffer_store_dword v49, v25, s[64:67], s47 offen offset:1024
    s_add_u32 s47, s47, 524288
    s_barrier
    ds_read_b64 v[32:33], v24 offset:8192
    ds_read_b64 v[34:35], v24 offset:9216
    ds_read_b64 v[36:37], v24 offset:10240
    ds_read_b64 v[38:39], v24 offset:11264
    s_waitcnt lgkmcnt(2)
    v_add_f32 v32, v32, v60
    v_add_f32 v33, v33, v61
    v_add_f32 v32, v32, v34
    v_add_f32 v33, v33, v35
    s_waitcnt lgkmcnt(0)
    v_add_f32 v36, v36, v62
    v_add_f32 v37, v37, v63
    v_add_f32 v36, v36, v38
    v_add_f32 v37, v37, v39
    v_cvt_pk_bf16_f32 v50, v32, v36
    buffer_store_dword v50, v25, s[64:67], s47 offen offset:0
    v_cvt_pk_bf16_f32 v51, v33, v37
    buffer_store_dword v51, v25, s[64:67], s47 offen offset:1024
    s_add_u32 s47, s47, 524288
    s_barrier
    ds_read_b64 v[32:33], v24 offset:16384
    ds_read_b64 v[34:35], v24 offset:17408
    ds_read_b64 v[36:37], v24 offset:18432
    ds_read_b64 v[38:39], v24 offset:19456
    s_waitcnt lgkmcnt(2)
    v_add_f32 v32, v32, v64
    v_add_f32 v33, v33, v65
    v_add_f32 v32, v32, v34
    v_add_f32 v33, v33, v35
    s_waitcnt lgkmcnt(0)
    v_add_f32 v36, v36, v66
    v_add_f32 v37, v37, v67
    v_add_f32 v36, v36, v38
    v_add_f32 v37, v37, v39
    v_cvt_pk_bf16_f32 v52, v32, v36
    buffer_store_dword v52, v25, s[64:67], s47 offen offset:0
    v_cvt_pk_bf16_f32 v53, v33, v37
    buffer_store_dword v53, v25, s[64:67], s47 offen offset:1024
    s_add_u32 s47, s47, 524288
    s_barrier
    ds_read_b64 v[32:33], v24 offset:24576
    ds_read_b64 v[34:35], v24 offset:25600
    ds_read_b64 v[36:37], v24 offset:26624
    ds_read_b64 v[38:39], v24 offset:27648
    s_waitcnt lgkmcnt(2)
    v_add_f32 v32, v32, v68
    v_add_f32 v33, v33, v69
    v_add_f32 v32, v32, v34
    v_add_f32 v33, v33, v35
    s_waitcnt lgkmcnt(0)
    v_add_f32 v36, v36, v70
    v_add_f32 v37, v37, v71
    v_add_f32 v36, v36, v38
    v_add_f32 v37, v37, v39
    v_cvt_pk_bf16_f32 v54, v32, v36
    buffer_store_dword v54, v25, s[64:67], s47 offen offset:0
    v_cvt_pk_bf16_f32 v55, v33, v37
    buffer_store_dword v55, v25, s[64:67], s47 offen offset:1024
L_C_fin:
    s_cmp_lg_u32 s68, 0
    s_cbranch_scc1 L_done
    s_waitcnt vmcnt(0) lgkmcnt(0)
    s_barrier
    s_add_u32 s69, s69, 1
    s_cmp_lg_u32 s28, 3
    s_cbranch_scc1 L_arr0_C
    s_and_b32 s30, s2, 15
    s_lshl_b32 s30, s30, 8
    s_add_u32 s31, s30, 0xeb0000
    v_mov_b32 v2, 1
    v_mov_b32 v3, 0
    s_mov_b64 exec, 1
    buffer_atomic_add v2, v3, s[20:23], s31 offen sc0 sc1
    s_mov_b64 exec, -1
L_arr0_C:
    s_cmp_lg_u32 s28, 3
    s_cbranch_scc1 L_arr_C
    s_lshl_b32 s31, s69, 4
    s_sub_u32 s31, s31, 1
    s_waitcnt vmcnt(0)
    v_readfirstlane_b32 s32, v2
    s_nop 0
    s_cmp_lg_u32 s32, s31
    s_cbranch_scc1 L_arr_C
    v_mov_b32 v2, 1
    v_lshlrev_b32 v3, 8, v1
    s_mov_b32 s30, 0xec0000
    buffer_atomic_add v2, v3, s[20:23], s30 offen sc1
    s_mov_b64 exec, -1
L_arr_C:
    s_mov_b32 s68, 0x440000
    s_branch L_A
L_done:
L_exit:
    s_endpgm
.p2align 8
L_pad:
    s_endpgm
.fill 1088, 4, 0xBF810000
.section .rodata,"a"
.p2align 6
.amdhsa_kernel interleave_layers__linear_attn_block__ssm_conv_s4__prompt_kernel
  .amdhsa_next_free_vgpr 256
  .amdhsa_next_free_sgpr 102
  .amdhsa_accum_offset 256
  .amdhsa_group_segment_fixed_size 0
  .amdhsa_kernarg_size 120
  .amdhsa_user_sgpr_count 2
  .amdhsa_user_sgpr_kernarg_segment_ptr 1
  .amdhsa_system_sgpr_workgroup_id_x 1
.end_amdhsa_kernel
```
